```python
import torch

def _softmax(x, axis=-1):
    return torch.softmax(x, dim=axis)
def _gelu(x):
    return torch.nn.functional.gelu(x, approximate="tanh")
def _silu(x):
    return torch.nn.functional.silu(x)
def _sigmoid(x):
    return torch.sigmoid(x)
def _layernorm(x, axis=-1, eps=1e-5):
    m = x.mean(dim=axis, keepdim=True)
    v = x.var(dim=axis, keepdim=True, unbiased=False)
    return (x - m) / torch.sqrt(v + eps)
def _scatter_add(tgt, idx, src, axis=0):
    return tgt.clone().index_add_(axis, idx, src)
def _segment_sum(src, seg, n):
    out = torch.zeros((n,) + src.shape[1:], dtype=src.dtype)
    return out.index_add_(0, seg, src)
def _pad(x, pw):
    flat = tuple(v for pair in reversed(pw) for v in pair)
    return torch.nn.functional.pad(x, flat)

kernel_name = 'recurrent_scan__compressed_kv_cla__dense_activation_relu__decode'

def setup_inputs():

    _w = (lambda a: (lambda t: t.to(torch.bfloat16) if t.is_floating_point() else t)(torch.as_tensor(a)))
    def _A_setup():
        B, H, Sq, Sk, D, M = 1, 32, 1, 16384, 128, 640
        Dc = 4 * D
        return {
            "x": _w((lambda *s: torch.randn(*s, dtype=torch.bfloat16) * 0.05)(B, Sq, M)),
            "c_kv": _w((lambda *s: torch.randn(*s, dtype=torch.bfloat16) * 0.8)(B, Sk, Dc)),
            "w_q": _w((lambda *s: torch.randn(*s, dtype=torch.bfloat16) * 1.6)(M, H, D) * (M ** -0.5)),
            "w_uk": _w((lambda *s: torch.randn(*s, dtype=torch.bfloat16) * 1.6)(Dc, H, D) * (Dc ** -0.5)),
            "w_uv": _w((lambda *s: torch.randn(*s, dtype=torch.bfloat16) * 0.8)(Dc, H, D) * (Dc ** -0.5)),
            "w_o": _w((lambda *s: torch.randn(*s, dtype=torch.bfloat16) * 0.8)(H, D, M) * ((H * D) ** -0.5)),
        }
    _A_in = _A_setup()

    def _B_setup():
        B, S, D, Dff = 1, 1, 640, 1728
        return {
            "x": _w((lambda *s: torch.randn(*s, dtype=torch.bfloat16) * 0.05)(B, S, D)),
            "w1": _w((lambda *s: torch.randn(*s, dtype=torch.bfloat16) * 0.2)(D, Dff)),
            "w2": _w((lambda *s: torch.randn(*s, dtype=torch.bfloat16) * 0.2)(Dff, D)),
        }
    _B_in = _B_setup()

    return {
        "A_x": _A_in["x"],
        "A_c_kv": _A_in["c_kv"],
        "A_w_q": _A_in["w_q"],
        "A_w_uk": _A_in["w_uk"],
        "A_w_uv": _A_in["w_uv"],
        "A_w_o": _A_in["w_o"],
        "B_x": _B_in["x"],
        "B_w1": _B_in["w1"],
        "B_w2": _B_in["w2"],
    }

def reference(A_x, A_c_kv, A_w_q, A_w_uk, A_w_uv, A_w_o, B_x, B_w1, B_w2):
    def _A_ref(x, c_kv, w_q, w_uk, w_uv, w_o):
        B, Sq, M = x.shape[0], x.shape[1], x.shape[2]
        Sk = c_kv.shape[1]
        H, D = w_q.shape[1], w_q.shape[2]
        q = torch.einsum("bqm,mhd->bhqd", x, w_q)
        k = torch.einsum("bkc,chd->bhkd", c_kv, w_uk)
        v = torch.einsum("bkc,chd->bhkd", c_kv, w_uv)
        scores = torch.einsum("bhqd,bhkd->bhqk", q, k) * (D ** -0.5)
        off = Sk - Sq
        qi = torch.arange(Sq)[:, None]
        kj = torch.arange(Sk)[None, :]
        cmask = kj <= (qi + off)
        scores = torch.where(cmask[None, None], scores, -1e9)
        p = _softmax(scores, axis=-1)
        ctx = torch.einsum("bhqk,bhkd->bhqd", p, v)
        return torch.einsum("bhqd,hdm->bqm", ctx, w_o)

    def _B_ref(x, w1, w2):
        h = torch.einsum("bsd,df->bsf", x, w1)
        zero = torch.zeros_like(h)
        h = torch.maximum(h, zero)
        return torch.einsum("bsf,fd->bsd", h, w2)

    x = A_x
    xn = _layernorm(x, axis=-1)
    s = _A_ref(xn, A_c_kv, A_w_q, A_w_uk, A_w_uv, A_w_o)
    g = _silu(_B_ref(xn, B_w1, B_w2))
    return x + s * g
```

```asm
; @launch grid=(256,1,1) block=(512,1,1) lds=163840
.amdgcn_target "amdgcn-amd-amdhsa--gfx950"
.text
.globl recurrent_scan__compressed_kv_cla__dense_activation_relu__decode_kernel
.p2align 8
.type recurrent_scan__compressed_kv_cla__dense_activation_relu__decode_kernel,@function
recurrent_scan__compressed_kv_cla__dense_activation_relu__decode_kernel:
    s_cmp_ge_u32 s2, 256
    s_cbranch_scc1 L_end
    s_load_dwordx16 s[4:19], s[0:1], 0
    s_load_dwordx8 s[20:27], s[0:1], 64
    s_getpc_b64 s[60:61]
L_pc:
    v_lshrrev_b32 v4, 6, v0
    v_and_b32 v2, 15, v0
    v_lshl_add_u32 v5, v4, 4, v2
    v_lshlrev_b32 v5, 7, v5
    v_min_u32 v5, L_end-L_pc, v5
    s_mov_b64 exec, 0xffff
    global_load_dword v208, v5, s[60:61]
    s_mov_b64 exec, -1
    v_and_b32 v1, 63, v0
    v_readfirstlane_b32 s3, v4
    v_lshrrev_b32 v3, 4, v1
    v_lshlrev_b32 v12, 4, v1
    s_and_b32 s30, s2, 7
    s_lshr_b32 s31, s2, 6
    s_lshl_b32 s31, s31, 3
    s_or_b32 s30, s30, s31
    s_lshr_b32 s31, s2, 4
    s_and_b32 s31, s31, 3
    s_lshl_b32 s28, s30, 2
    s_or_b32 s28, s28, s31
    s_mov_b32 s39, 65536
    s_mov_b32 s42, 33554432
    s_mov_b32 s43, 0x20000
    s_mov_b32 s47, 0x20000
    s_mov_b32 s51, 0x20000
    s_mov_b32 s55, 0x20000
    s_mov_b32 s59, 0x20000
    s_bitcmp1_b32 s2, 3
    s_cbranch_scc1 L_KV
    s_and_b32 s33, s3, 1
    s_lshl_b32 s33, s33, 2
    v_add_u32 v5, s33, v3
    v_lshlrev_b32 v5, 1, v5
    v_xor_b32 v5, v5, v2
    v_lshlrev_b32 v5, 4, v5
    v_lshl_add_u32 v6, v3, 13, v5
    s_mul_i32 s32, s31, 160
    s_lshl_b32 s35, s3, 2
    s_add_u32 s32, s32, s35
    s_lshl_b32 s32, s32, 13
    s_lshl_b32 s34, s30, 8
    s_add_u32 s32, s32, s34
    s_lshl_b32 s33, s3, 10
    s_lshl_b32 s36, s31, 7
    s_add_u32 s36, s36, s35
    s_lshl_b32 s36, s36, 13
    s_add_u32 s36, s36, s34
    s_lshl_b32 s64, s30, 12
    s_add_u32 s64, s64, 65536
    v_lshrrev_b32 v7, 2, v2
    v_and_b32 v14, 1, v3
    v_lshl_add_u32 v14, v14, 2, v7
    v_lshl_add_u32 v7, v3, 2, v7
    v_bfe_u32 v15, v2, 1, 1
    s_lshl_b32 s37, s3, 1
    v_add_u32 v15, s37, v15
    v_lshlrev_b32 v28, 1, v14
    v_xor_b32 v15, v15, v28
    v_lshlrev_b32 v15, 4, v15
    v_lshl_add_u32 v15, v7, 8, v15
    v_and_b32 v13, 1, v2
    v_lshl_add_u32 v15, v13, 3, v15
    v_lshlrev_b32 v28, 4, v3
    v_add_u32 v29, 73728, v28
    v_add_u32 v28, 76352, v28
    v_lshlrev_b32 v30, 5, v3
    v_lshl_add_u32 v30, v13, 4, v30
    v_cmp_eq_u32 s[62:63], 1, v13
    s_lshl_b32 s70, s28, 10
    s_lshl_b32 s37, s3, 7
    s_add_u32 s70, s70, s37
    s_add_u32 s70, s70, 65536
    v_and_b32 v5, 7, v2
    v_lshlrev_b32 v5, 1, v5
    v_xor_b32 v5, v5, v3
    v_lshlrev_b32 v5, 4, v5
    v_lshl_add_u32 v92, v2, 8, v5
    s_lshl_b32 s37, s3, 12
    v_add_u32 v92, s37, v92
    v_xor_b32 v93, 64, v92
    v_xor_b32 v94, 0x80, v92
    v_xor_b32 v95, 0xc0, v92
    s_lshl_b32 s37, s3, 5
    s_add_u32 s37, s37, 0
    v_lshl_add_u32 v96, v3, 3, s37
    s_mov_b32 s71, 0x3e0293ee
    s_lshl_b32 s72, s28, 8
    s_add_u32 s72, s72, 262144
    v_add_u32 v97, 76608, v12
    v_lshlrev_b32 v98, 2, v1
    v_add_u32 v98, 76352, v98
    s_add_u32 s66, s70, 6225920
    s_add_u32 s67, s64, 6225920
    s_mov_b32 s68, 0
    s_waitcnt lgkmcnt(0)
    s_load_dword s29, s[26:27], 0
    s_mov_b32 s40, s26
    s_and_b32 s41, s27, 0xffff
    s_mov_b32 s44, s8
    s_and_b32 s45, s9, 0xffff
    s_mov_b32 s46, 5242880
    s_cmp_eq_u32 s3, 5
    s_cbranch_scc0 L_w_not_ln
    s_mov_b32 s52, s4
    s_and_b32 s53, s5, 0xffff
    s_mov_b32 s54, 1280
    v_lshlrev_b32 v4, 2, v1
    buffer_load_dword v16, v4, s[52:55], 0 offen offset:0
    buffer_load_dword v17, v4, s[52:55], 0 offen offset:256
    buffer_load_dword v18, v4, s[52:55], 0 offen offset:512
    buffer_load_dword v19, v4, s[52:55], 0 offen offset:768
    buffer_load_dword v20, v4, s[52:55], 0 offen offset:1024
    s_mul_i32 s37, s31, 320
    buffer_load_dword v21, v4, s[52:55], s37 offen offset:0
    buffer_load_dword v22, v4, s[52:55], s37 offen offset:256
L_w_not_ln:
    s_cmp_eq_u32 s3, 7
    s_cbranch_scc0 L_w_not7
    v_mov_b32 v8, -1
    v_mov_b32 v9, -1
    v_mov_b32 v10, -1
    v_mov_b32 v11, -1
    s_mov_b64 exec, 0xffff
    buffer_store_dwordx4 v[8:11], v12, s[40:43], s72 offen sc1
    s_mov_b64 exec, -1
L_w_not7:
    s_add_u32 m0, s33, 0
    s_nop 0
    buffer_load_dwordx4 v6, s[44:47], s32 offen lds
    s_add_u32 m0, s33, 8192
    s_add_u32 s32, s32, 262144
    buffer_load_dwordx4 v6, s[44:47], s32 offen lds
    s_add_u32 m0, s33, 16384
    s_add_u32 s32, s32, 262144
    buffer_load_dwordx4 v6, s[44:47], s32 offen lds
    s_add_u32 m0, s33, 24576
    s_add_u32 s32, s32, 262144
    buffer_load_dwordx4 v6, s[44:47], s32 offen lds
    s_add_u32 m0, s33, 32768
    s_add_u32 s32, s32, 262144
    buffer_load_dwordx4 v6, s[44:47], s32 offen lds
    s_mov_b32 s48, s10
    s_and_b32 s49, s11, 0xffff
    s_mov_b32 s50, 4194304
    s_mov_b32 s38, s36
    s_barrier
    s_cmp_eq_u32 s3, 5
    s_cbranch_scc0 L_w_ln_done
    v_and_b32 v4, 0x31, v1
    v_and_b32 v5, 6, v1
    v_lshl_or_b32 v4, v5, 1, v4
    v_bfe_u32 v5, v1, 3, 1
    v_lshl_or_b32 v4, v5, 1, v4
    v_lshlrev_b32 v4, 2, v4
    v_add_u32 v4, 73728, v4
    s_waitcnt vmcnt(5)
    v_readfirstlane_b32 s37, v16
    s_nop 0
    s_lshl_b32 s37, s37, 16
    v_lshlrev_b32 v32, 16, v16
    v_and_b32 v33, 0xffff0000, v16
    v_lshlrev_b32 v34, 16, v17
    v_and_b32 v35, 0xffff0000, v17
    v_lshlrev_b32 v36, 16, v18
    v_and_b32 v37, 0xffff0000, v18
    v_lshlrev_b32 v38, 16, v19
    v_and_b32 v39, 0xffff0000, v19
    v_lshlrev_b32 v40, 16, v20
    v_and_b32 v41, 0xffff0000, v20
    v_subrev_f32 v32, s37, v32
    v_subrev_f32 v33, s37, v33
    v_subrev_f32 v34, s37, v34
    v_subrev_f32 v35, s37, v35
    v_subrev_f32 v36, s37, v36
    v_subrev_f32 v37, s37, v37
    v_subrev_f32 v38, s37, v38
    v_subrev_f32 v39, s37, v39
    v_subrev_f32 v40, s37, v40
    v_subrev_f32 v41, s37, v41
    v_pk_add_f32 v[42:43], v[32:33], v[34:35]
    v_pk_mul_f32 v[44:45], v[32:33], v[32:33]
    v_pk_fma_f32 v[44:45], v[34:35], v[34:35], v[44:45]
    v_pk_add_f32 v[42:43], v[42:43], v[36:37]
    v_pk_fma_f32 v[44:45], v[36:37], v[36:37], v[44:45]
    v_pk_add_f32 v[42:43], v[42:43], v[38:39]
    v_pk_fma_f32 v[44:45], v[38:39], v[38:39], v[44:45]
    v_pk_add_f32 v[42:43], v[42:43], v[40:41]
    v_pk_fma_f32 v[44:45], v[40:41], v[40:41], v[44:45]
    v_add_f32 v42, v42, v43
    v_add_f32 v44, v44, v45
    s_nop 0
    v_add_f32 v42, v42, v42 row_ror:8 row_mask:0xf bank_mask:0xf
    v_add_f32 v44, v44, v44 row_ror:8 row_mask:0xf bank_mask:0xf
    s_nop 0
    v_add_f32 v42, v42, v42 row_ror:4 row_mask:0xf bank_mask:0xf
    v_add_f32 v44, v44, v44 row_ror:4 row_mask:0xf bank_mask:0xf
    s_nop 0
    v_add_f32 v42, v42, v42 row_ror:2 row_mask:0xf bank_mask:0xf
    v_add_f32 v44, v44, v44 row_ror:2 row_mask:0xf bank_mask:0xf
    s_nop 0
    v_add_f32 v42, v42, v42 row_ror:1 row_mask:0xf bank_mask:0xf
    v_add_f32 v44, v44, v44 row_ror:1 row_mask:0xf bank_mask:0xf
    v_mov_b32 v43, v42
    v_mov_b32 v45, v44
    s_nop 0
    v_permlane16_swap_b32 v42, v43
    v_permlane16_swap_b32 v44, v45
    v_add_f32 v42, v42, v43
    v_add_f32 v44, v44, v45
    v_mov_b32 v43, v42
    v_mov_b32 v45, v44
    s_nop 0
    v_permlane32_swap_b32 v42, v43
    v_permlane32_swap_b32 v44, v45
    v_add_f32 v42, v42, v43
    v_add_f32 v44, v44, v45
    v_mul_f32 v42, 0x3acccccd, v42
    v_mul_f32 v44, 0x3acccccd, v44
    v_fma_f32 v44, -v42, v42, v44
    v_max_f32 v44, 0, v44
    v_add_f32 v42, s37, v42
    v_cvt_pk_bf16_f32 v42, v42, v44
    v_and_b32 v44, 0xffff0000, v42
    v_lshlrev_b32 v42, 16, v42
    v_add_f32 v44, 0x3727c5ac, v44
    v_cvt_pk_bf16_f32 v44, v44, v44
    v_and_b32 v44, 0xffff0000, v44
    v_sqrt_f32 v44, v44
    s_nop 0
    v_cvt_pk_bf16_f32 v44, v44, v44
    v_and_b32 v44, 0xffff0000, v44
    v_lshlrev_b32 v32, 16, v21
    v_and_b32 v33, 0xffff0000, v21
    v_lshlrev_b32 v34, 16, v22
    v_and_b32 v35, 0xffff0000, v22
    v_rcp_f32 v46, v44
    v_sub_f32 v32, v32, v42
    v_sub_f32 v33, v33, v42
    v_sub_f32 v34, v34, v42
    v_sub_f32 v35, v35, v42
    v_fma_f32 v47, -v44, v46, 1.0
    v_fma_f32 v46, v47, v46, v46
    v_cvt_pk_bf16_f32 v21, v32, v33
    v_cvt_pk_bf16_f32 v22, v34, v35
    v_lshlrev_b32 v32, 16, v21
    v_and_b32 v33, 0xffff0000, v21
    v_lshlrev_b32 v34, 16, v22
    v_and_b32 v35, 0xffff0000, v22
    v_mul_f32 v42, v32, v46
    v_mul_f32 v43, v33, v46
    v_fma_f32 v32, -v42, v44, v32
    v_fma_f32 v33, -v43, v44, v33
    v_fma_f32 v32, v32, v46, v42
    v_fma_f32 v33, v33, v46, v43
    v_cvt_pk_bf16_f32 v21, v32, v33
    ds_write_b32 v4, v21 offset:0
    v_mul_f32 v42, v34, v46
    v_mul_f32 v43, v35, v46
    v_fma_f32 v34, -v42, v44, v34
    v_fma_f32 v35, -v43, v44, v35
    v_fma_f32 v34, v34, v46, v42
    v_fma_f32 v35, v35, v46, v43
    v_cvt_pk_bf16_f32 v22, v34, v35
    ds_write_b32 v4, v22 offset:256
L_w_ln_done:
    s_cmp_eq_u32 s3, 7
    s_cbranch_scc0 L_w_nofl
    s_lshl_b32 s37, s28, 7
    s_add_u32 s37, s37, 4096
    s_waitcnt vmcnt(5) lgkmcnt(0)
    s_add_u32 s73, s29, 1
    v_mov_b32 v5, s73
    s_mov_b64 exec, 1
    buffer_store_dword v5, v12, s[40:43], s37 offen sc1
    s_mov_b64 exec, -1
L_w_nofl:
    s_lshl_b32 s37, s3, 9
    s_add_u32 s37, s37, s67
    s_mov_b32 exec_hi, 0
    buffer_load_dwordx4 v[100:103], v12, s[40:43], s37 offen sc1
    s_mov_b32 exec_hi, -1
    s_add_u32 m0, s33, 40960
    s_nop 0
    buffer_load_dwordx4 v6, s[48:51], s38 offen lds
    s_getreg_b32 s79, hwreg(HW_REG_XCC_ID)
    s_and_b32 s79, s79, 15
    s_add_u32 s79, s79, 1
    s_lshl_b32 s79, s79, 27
    s_waitcnt lgkmcnt(0)
    s_add_u32 s29, s29, 1
    s_xor_b32 s79, s79, s29
    v_mov_b32 v9, s79
    v_mov_b32 v11, s79
    v_mov_b32 v19, s79
    s_cmp_eq_u32 s3, 7
    s_cbranch_scc1 L_w_w7
    s_waitcnt vmcnt(2)
L_w_w7:
    s_waitcnt vmcnt(3)
    s_barrier
    ds_read_b64_tr_b16 v[48:49], v15 offset:0
    ds_read_b64_tr_b16 v[50:51], v15 offset:4096
    ds_read_b128 v[68:71], v29 offset:0
    ds_read_b64_tr_b16 v[52:53], v15 offset:8192
    ds_read_b64_tr_b16 v[54:55], v15 offset:12288
    ds_read_b128 v[72:75], v29 offset:64
    ds_read_b64_tr_b16 v[56:57], v15 offset:16384
    ds_read_b64_tr_b16 v[58:59], v15 offset:20480
    ds_read_b128 v[76:79], v29 offset:128
    ds_read_b64_tr_b16 v[60:61], v15 offset:24576
    ds_read_b64_tr_b16 v[62:63], v15 offset:28672
    ds_read_b128 v[80:83], v29 offset:192
    ds_read_b64_tr_b16 v[64:65], v15 offset:32768
    ds_read_b64_tr_b16 v[66:67], v15 offset:36864
    ds_read_b128 v[84:87], v29 offset:256
    s_add_u32 m0, s33, 49152
    s_add_u32 s38, s38, 262144
    buffer_load_dwordx4 v6, s[48:51], s38 offen lds
    s_add_u32 m0, s33, 57344
    s_add_u32 s38, s38, 262144
    buffer_load_dwordx4 v6, s[48:51], s38 offen lds
    s_add_u32 m0, s33, 65536
    s_add_u32 s38, s38, 262144
    buffer_load_dwordx4 v6, s[48:51], s38 offen lds
    s_waitcnt lgkmcnt(12)
    v_mfma_f32_16x16x32_bf16 v[88:91], v[48:51], v[68:71], 0
    s_waitcnt lgkmcnt(9)
    v_mfma_f32_16x16x32_bf16 v[88:91], v[52:55], v[72:75], v[88:91]
    s_waitcnt lgkmcnt(6)
    v_mfma_f32_16x16x32_bf16 v[88:91], v[56:59], v[76:79], v[88:91]
    s_waitcnt lgkmcnt(3)
    v_mfma_f32_16x16x32_bf16 v[88:91], v[60:63], v[80:83], v[88:91]
    s_waitcnt lgkmcnt(0)
    v_mfma_f32_16x16x32_bf16 v[88:91], v[64:67], v[84:87], v[88:91]
    s_mov_b32 exec_lo, 0x00030003
    s_mov_b32 exec_hi, 0x00030003
    s_nop 5
    v_cndmask_b32 v8, v88, v90, s[62:63]
    v_cndmask_b32 v10, v89, v91, s[62:63]
    buffer_store_dwordx4 v[8:11], v30, s[40:43], s66 offen
    s_mov_b64 exec, -1
    v_mov_b32 v99, 76304
    s_cmp_eq_u32 s3, 7
    s_cbranch_scc1 L_w_h1p
    s_waitcnt vmcnt(1)
    s_branch L_w_h1other
L_w_h1p:
    s_mov_b32 s69, s67
L_w_h1:
    buffer_load_dwordx4 v[48:51], v12, s[40:43], s69 offen offset:0 sc1
    buffer_load_dwordx4 v[52:55], v12, s[40:43], s69 offen offset:1024 sc1
    buffer_load_dwordx4 v[56:59], v12, s[40:43], s69 offen offset:2048 sc1
    buffer_load_dwordx4 v[60:63], v12, s[40:43], s69 offen offset:3072 sc1
    s_waitcnt vmcnt(0)
    v_xor_b32 v5, v49, v19
    v_xor_b32 v16, v51, v19
    v_xor_b32 v17, v53, v19
    v_xor_b32 v18, v55, v19
    v_or3_b32 v5, v5, v16, v17
    v_xor_b32 v16, v57, v19
    v_xor_b32 v17, v59, v19
    v_or3_b32 v5, v5, v18, v16
    v_xor_b32 v16, v61, v19
    v_xor_b32 v18, v63, v19
    v_or3_b32 v5, v5, v17, v16
    v_or_b32 v5, v5, v18
    v_add_f32 v48, v48, v52
    v_add_f32 v50, v50, v54
    v_cmp_ne_u32 vcc, 0, v5
    v_add_f32 v56, v56, v60
    v_add_f32 v58, v58, v62
    s_cmp_lg_u64 vcc, 0
    s_cbranch_scc0 L_w_h1ok
    s_add_u32 s68, s68, 1
    s_cmp_lt_u32 s68, 24
    s_cbranch_scc1 L_w_h1
    s_cmp_eq_u32 s68, 24
    s_cbranch_scc0 L_w_h1b
    v_mov_b32 v5, 1
    ds_write_b32 v99, v5
    s_waitcnt lgkmcnt(0)
    s_barrier
    v_mov_b32 v9, s29
    v_mov_b32 v11, s29
    s_mov_b32 exec_lo, 0x00030003
    s_mov_b32 exec_hi, 0x00030003
    buffer_store_dwordx4 v[8:11], v30, s[40:43], s70 offen sc1
    s_mov_b64 exec, -1
    s_barrier
L_w_h1b:
    s_bitcmp1_b32 s68, 0
    s_cselect_b32 s69, s67, s64
    s_cselect_b32 s37, s79, s29
    v_mov_b32 v19, s37
    s_sub_u32 s39, s39, 1
    s_cbranch_scc0 L_w_h1
    s_mov_b32 s39, 0
L_w_h1ok:
    v_add_f32 v48, v48, v56
    v_add_f32 v50, v50, v58
    v_mov_b32 v5, 0
    v_cvt_pk_bf16_f32 v48, v48, v50
    ds_write_b32 v98, v48
    ds_write_b32 v99, v5
    s_waitcnt lgkmcnt(0)
L_w_h1other:
    s_barrier
    ds_read_b32 v5, v99
    ds_read_b128 v[68:71], v28 offset:0
    ds_read_b128 v[32:35], v92 offset:40960
    ds_read_b128 v[72:75], v28 offset:64
    ds_read_b128 v[36:39], v93 offset:40960
    ds_read_b128 v[76:79], v28 offset:128
    ds_read_b128 v[40:43], v94 offset:40960
    ds_read_b128 v[80:83], v28 offset:192
    ds_read_b128 v[44:47], v95 offset:40960
    s_waitcnt lgkmcnt(8)
    v_cmp_ne_u32 vcc, 0, v5
    s_cbranch_vccz L_w_h1go
    v_mov_b32 v9, s29
    v_mov_b32 v11, s29
    s_mov_b32 exec_lo, 0x00030003
    s_mov_b32 exec_hi, 0x00030003
    buffer_store_dwordx4 v[8:11], v30, s[40:43], s70 offen sc1
    s_mov_b64 exec, -1
    s_waitcnt lgkmcnt(0)
    s_barrier
    s_branch L_w_h1other
L_w_h1go:
    s_waitcnt lgkmcnt(6)
    v_mfma_f32_16x16x32_bf16 v[88:91], v[32:35], v[68:71], 0
    s_waitcnt lgkmcnt(4)
    v_mfma_f32_16x16x32_bf16 v[88:91], v[36:39], v[72:75], v[88:91]
    s_waitcnt lgkmcnt(2)
    v_mfma_f32_16x16x32_bf16 v[88:91], v[40:43], v[76:79], v[88:91]
    s_waitcnt lgkmcnt(0)
    v_mfma_f32_16x16x32_bf16 v[88:91], v[44:47], v[80:83], v[88:91]
    s_mov_b32 exec_lo, 0x00010001
    s_mov_b32 exec_hi, 0x00010001
    s_nop 5
    v_mul_f32 v88, s71, v88
    v_mul_f32 v89, s71, v89
    v_mul_f32 v90, s71, v90
    v_mul_f32 v91, s71, v91
    v_cvt_pk_bf16_f32 v16, v88, v89
    v_cvt_pk_bf16_f32 v17, v90, v91
    v_min_u32 v16, -2, v16
    v_min_u32 v17, -2, v17
    buffer_store_dwordx2 v[16:17], v96, s[40:43], s72 offen sc1
    s_mov_b64 exec, -1
    s_mov_b32 s44, s14
    s_and_b32 s45, s15, 0xffff
    s_mov_b32 s46, 5242880
    s_mov_b32 s48, s12
    s_and_b32 s49, s13, 0xffff
    s_mov_b32 s50, 4194304
    s_and_b32 s37, s3, 1
    s_lshl_b32 s37, s37, 2
    v_add_u32 v5, 0, v3
    v_mul_u32_u24 v5, 13, v5
    v_lshrrev_b32 v5, 6, v5
    v_mul_u32_u24 v21, 0x500, v5
    v_add_u32 v22, 0, v12
    v_sub_u32 v22, v22, v21
    v_add_u32 v5, s37, v5
    v_lshlrev_b32 v5, 5, v5
    v_xor_b32 v22, v22, v5
    v_add_u32 v16, v21, v22
    v_add_u32 v5, 4, v3
    v_mul_u32_u24 v5, 13, v5
    v_lshrrev_b32 v5, 6, v5
    v_mul_u32_u24 v21, 0x500, v5
    v_add_u32 v22, 1024, v12
    v_sub_u32 v22, v22, v21
    v_add_u32 v5, s37, v5
    v_lshlrev_b32 v5, 5, v5
    v_xor_b32 v22, v22, v5
    v_add_u32 v17, v21, v22
    v_add_u32 v5, 8, v3
    v_mul_u32_u24 v5, 13, v5
    v_lshrrev_b32 v5, 6, v5
    v_mul_u32_u24 v21, 0x500, v5
    v_add_u32 v22, 2048, v12
    v_sub_u32 v22, v22, v21
    v_add_u32 v5, s37, v5
    v_lshlrev_b32 v5, 5, v5
    v_xor_b32 v22, v22, v5
    v_add_u32 v18, v21, v22
    v_add_u32 v5, 12, v3
    v_mul_u32_u24 v5, 13, v5
    v_lshrrev_b32 v5, 6, v5
    v_mul_u32_u24 v21, 0x500, v5
    v_add_u32 v22, 3072, v12
    v_sub_u32 v22, v22, v21
    v_add_u32 v5, s37, v5
    v_lshlrev_b32 v5, 5, v5
    v_xor_b32 v22, v22, v5
    v_add_u32 v19, v21, v22
    v_add_u32 v5, 16, v3
    v_mul_u32_u24 v5, 13, v5
    v_lshrrev_b32 v5, 6, v5
    v_mul_u32_u24 v21, 0x500, v5
    v_add_u32 v22, 4096, v12
    v_sub_u32 v22, v22, v21
    v_add_u32 v5, s37, v5
    v_lshlrev_b32 v5, 5, v5
    v_xor_b32 v22, v22, v5
    v_add_u32 v20, v21, v22
    s_barrier
    s_lshl_b32 s68, s28, 15
    s_lshl_b32 s37, s3, 12
    s_add_u32 s68, s68, s37
    s_add_u32 s68, s68, 2097152
    v_mov_b32 v52, -1
    v_mov_b32 v53, -1
    v_mov_b32 v54, -1
    v_mov_b32 v55, -1
    s_lshl_b32 s69, s30, 10
    s_lshl_b32 s37, s3, 7
    s_add_u32 s69, s69, s37
    s_add_u32 s69, s69, 1835008
    s_mov_b32 s52, s6
    s_and_b32 s53, s7, 0xffff
    s_mov_b32 s54, 16777216
    s_lshl_b32 s37, s28, 17
    s_xor_b32 s38, s3, 0
    s_mul_i32 s38, s38, 8192
    s_add_u32 s37, s37, s38
    s_add_u32 s37, s37, 65536
    v_lshlrev_b32 v105, 7, v1
    buffer_load_dword v104, v105, s[52:55], s37 offen
    s_mov_b64 exec, -1
    s_waitcnt vmcnt(0)
    s_cmp_lg_u32 s3, 0
    s_cbranch_scc1 L_w_trgd
    s_lshl_b32 s37, s28, 7
    s_add_u32 s37, s37, 475136
L_w_trg:
    s_load_dword s38, s[26:27], s37 glc
    s_waitcnt lgkmcnt(0)
    s_cmp_lg_u32 s38, s29
    s_cbranch_scc0 L_w_trgok
    s_sub_u32 s39, s39, 1
    s_cbranch_scc0 L_w_trg
    s_mov_b32 s39, 0
L_w_trgok:
    s_mov_b64 exec, -1
L_w_trgd:
    s_barrier
    s_mov_b32 s32, s36
    s_add_u32 m0, s33, 82944
    s_nop 0
    buffer_load_dwordx4 v6, s[48:51], s32 offen nt lds
    s_add_u32 m0, s33, 91136
    s_add_u32 s32, s32, 262144
    buffer_load_dwordx4 v6, s[48:51], s32 offen nt lds
    s_add_u32 m0, s33, 99328
    s_add_u32 s32, s32, 262144
    buffer_load_dwordx4 v6, s[48:51], s32 offen nt lds
    s_add_u32 m0, s33, 107520
    s_add_u32 s32, s32, 262144
    buffer_load_dwordx4 v6, s[48:51], s32 offen nt lds
    s_mul_i32 s37, s3, 5120
    s_mul_i32 s32, s28, 40960
    s_add_u32 s32, s32, s37
    s_add_u32 m0, s37, 115712
    s_nop 0
    buffer_load_dwordx4 v16, s[44:47], s32 offen nt lds
    s_add_u32 m0, s37, 116736
    s_nop 0
    buffer_load_dwordx4 v17, s[44:47], s32 offen nt lds
    s_add_u32 m0, s37, 117760
    s_nop 0
    buffer_load_dwordx4 v18, s[44:47], s32 offen nt lds
    s_add_u32 m0, s37, 118784
    s_nop 0
    buffer_load_dwordx4 v19, s[44:47], s32 offen nt lds
    s_add_u32 m0, s37, 119808
    s_nop 0
    buffer_load_dwordx4 v20, s[44:47], s32 offen nt lds
    s_lshl_b32 s66, s28, 10
    s_add_u32 s66, s66, 327680
    s_add_u32 s64, s66, 6225920
    s_cmp_lg_u32 s3, 7
    s_cbranch_scc1 L_w_nopt
    buffer_load_dwordx4 v[92:95], v12, s[40:43], s64 offen sc1
L_w_nopt:
    v_add_u32 v16, 82944, v15
    v_lshrrev_b32 v5, 2, v2
    v_and_b32 v8, 1, v3
    v_lshl_add_u32 v8, v8, 2, v5
    v_lshl_add_u32 v5, v3, 2, v5
    v_mul_u32_u24 v40, 0x500, v5
    v_bfe_u32 v5, v2, 1, 1
    v_xor_b32 v8, v5, v8
    v_lshl_add_u32 v40, v8, 5, v40
    v_and_b32 v8, 1, v2
    v_lshl_add_u32 v40, v8, 4, v40
    s_lshl_b32 s37, s3, 8
    v_add_u32 v40, s37, v40
    v_xor_b32 v41, 64, v40
    v_xor_b32 v42, 0x80, v40
    v_xor_b32 v43, 0xc0, v40
    v_add_u32 v40, 115712, v40
    v_add_u32 v41, 115712, v41
    v_add_u32 v42, 115712, v42
    v_add_u32 v43, 115712, v43
    v_and_b32 v5, 12, v2
    v_add_u32 v5, v5, v3
    v_lshlrev_b32 v21, 13, v5
    v_and_b32 v9, 3, v2
    v_lshl_add_u32 v21, v9, 4, v21
    v_and_b32 v9, 1, v3
    s_lshl_b32 s35, s3, 17
    s_lshl_b32 s37, s28, 6
    s_add_u32 s35, s35, s37
    s_add_u32 s35, s35, 524288
    s_lshl_b32 s63, s30, 12
    s_lshr_b32 s37, s3, 1
    s_lshl_b32 s37, s37, 10
    s_add_u32 s63, s63, s37
    s_lshl_b32 s37, s31, 8
    s_add_u32 s63, s63, s37
    s_and_b32 s37, s3, 1
    s_lshl_b32 s37, s37, 7
    s_add_u32 s63, s63, s37
    s_add_u32 s63, s63, 327680
    s_add_u32 s62, s63, 6225920
    s_add_u32 s36, s35, 655360
    v_lshlrev_b32 v18, 3, v3
    s_lshl_b32 s67, s28, 7
    s_add_u32 s67, s67, 458752
    s_lshl_b32 s37, s3, 1
    v_add_u32 v5, s37, v9
    v_mul_u32_u24 v19, 0x120, v5
    v_lshrrev_b32 v5, 2, v2
    v_lshl_add_u32 v19, v5, 6, v19
    v_lshl_add_u32 v19, v13, 5, v19
    v_lshrrev_b32 v5, 1, v3
    v_lshl_add_u32 v19, v5, 4, v19
    v_bfe_u32 v5, v2, 1, 1
    v_lshl_add_u32 v19, v5, 3, v19
    v_add_u32 v19, 76992, v19
    v_mul_u32_u24 v20, 0x120, v2
    v_lshl_add_u32 v20, v3, 4, v20
    v_add_u32 v20, 76992, v20
    v_lshlrev_b32 v23, 4, v3
    v_add_u32 v23, 76864, v23
    s_lshl_b32 s37, s3, 3
    s_add_u32 s37, s37, 76864
    v_mov_b32 v24, s37
    v_lshlrev_b32 v25, 3, v2
    v_bfe_u32 v5, v2, 1, 2
    v_lshlrev_b32 v22, 4, v5
    v_lshrrev_b32 v5, 3, v2
    v_lshl_add_u32 v22, v5, 3, v22
    v_lshl_add_u32 v22, v13, 2, v22
    v_add_u32 v22, 76928, v22
    s_lshl_b32 s37, s3, 2
    s_add_u32 s37, s37, 76864
    v_mov_b32 v27, s37
    v_mov_b32 v28, 76864
    v_mov_b32 v5, 0
    v_lshlrev_b32 v8, 2, v1
    v_add_u32 v8, 76352, v8
    ds_write_b32 v8, v5
    v_lshrrev_b32 v8, 1, v2
    v_add_u32 v5, 64, v23
    v_mov_b32 v11, 76352
    v_cmp_eq_u32 vcc, 0, v8
    s_nop 1
    v_cndmask_b32 v180, v11, v5, vcc
    v_cmp_eq_u32 vcc, 1, v8
    s_nop 1
    v_cndmask_b32 v181, v11, v5, vcc
    v_cmp_eq_u32 vcc, 2, v8
    s_nop 1
    v_cndmask_b32 v182, v11, v5, vcc
    v_cmp_eq_u32 vcc, 3, v8
    s_nop 1
    v_cndmask_b32 v183, v11, v5, vcc
    v_cmp_eq_u32 vcc, 4, v8
    s_nop 1
    v_cndmask_b32 v184, v11, v5, vcc
    v_cmp_eq_u32 vcc, 5, v8
    s_nop 1
    v_cndmask_b32 v185, v11, v5, vcc
    v_cmp_eq_u32 vcc, 6, v8
    s_nop 1
    v_cndmask_b32 v186, v11, v5, vcc
    v_cmp_eq_u32 vcc, 7, v8
    s_nop 1
    v_cndmask_b32 v187, v11, v5, vcc
    s_waitcnt lgkmcnt(0)
    s_waitcnt vmcnt(0)
    s_barrier
    ds_read_b64_tr_b16 v[132:133], v16 offset:0
    ds_read_b64_tr_b16 v[134:135], v16 offset:4096
    ds_read_b64_tr_b16 v[136:137], v16 offset:8192
    ds_read_b64_tr_b16 v[138:139], v16 offset:12288
    ds_read_b64_tr_b16 v[140:141], v16 offset:16384
    ds_read_b64_tr_b16 v[142:143], v16 offset:20480
    ds_read_b64_tr_b16 v[144:145], v16 offset:24576
    ds_read_b64_tr_b16 v[146:147], v16 offset:28672
    s_cmp_ge_u32 s3, 5
    s_cbranch_scc1 L_w_nowo
    s_waitcnt lgkmcnt(4)
    ds_read_b64_tr_b16 v[100:101], v40 offset:0
    ds_read_b64_tr_b16 v[102:103], v40 offset:20480
    ds_read_b64_tr_b16 v[104:105], v40 offset:8
    ds_read_b64_tr_b16 v[106:107], v40 offset:20488
    ds_read_b64_tr_b16 v[108:109], v41 offset:0
    ds_read_b64_tr_b16 v[110:111], v41 offset:20480
    s_waitcnt lgkmcnt(4)
    ds_read_b64_tr_b16 v[112:113], v41 offset:8
    ds_read_b64_tr_b16 v[114:115], v41 offset:20488
    ds_read_b64_tr_b16 v[116:117], v42 offset:0
    ds_read_b64_tr_b16 v[118:119], v42 offset:20480
    ds_read_b64_tr_b16 v[120:121], v42 offset:8
    ds_read_b64_tr_b16 v[122:123], v42 offset:20488
    s_waitcnt lgkmcnt(4)
    ds_read_b64_tr_b16 v[124:125], v43 offset:0
    ds_read_b64_tr_b16 v[126:127], v43 offset:20480
    ds_read_b64_tr_b16 v[128:129], v43 offset:8
    ds_read_b64_tr_b16 v[130:131], v43 offset:20488
L_w_nowo:
    v_lshl_add_u32 v10, v2, 2, v3
    v_lshlrev_b32 v10, 9, v10
    s_lshl_b32 s67, s3, 13
    s_lshl_b32 s37, s30, 4
    s_add_u32 s67, s67, s37
    s_add_u32 s67, s67, 1835008
    s_mov_b32 s70, 0x000f000f
    s_mov_b32 s71, 0x000f000f
    s_mov_b32 s74, 0x00010001
    s_mov_b32 s75, 0x00010001
    s_mov_b32 s78, 0xffff
L_w_g:
    s_mov_b64 exec, s[70:71]
    buffer_load_dwordx4 v[64:67], v10, s[40:43], s67 offen sc1
L_w_g1:
    s_waitcnt vmcnt(0)
    v_cmp_eq_u32 s[72:73], s29, v65
    v_cmp_eq_u32 vcc, s29, v67
    s_nop 0
    s_and_b64 s[72:73], s[72:73], vcc
    s_andn2_b64 s[70:71], s[70:71], s[72:73]
    s_cbranch_scc0 L_w_gok
    s_sub_u32 s39, s39, 1
    s_cbranch_scc0 L_w_g
    s_mov_b32 s39, 0
L_w_gok:
    s_mov_b64 exec, -1
    buffer_load_dwordx4 v[48:51], v12, s[40:43], s68 offen offset:0 sc1
    buffer_load_dwordx4 v[52:55], v12, s[40:43], s68 offen offset:1024 sc1
    buffer_load_dwordx4 v[56:59], v12, s[40:43], s68 offen offset:2048 sc1
    buffer_load_dwordx4 v[60:63], v12, s[40:43], s68 offen offset:3072 sc1
    v_max_f32 v26, v64, v64 quad_perm:[1,0,3,2] row_mask:0xf bank_mask:0xf
    s_nop 1
    v_max_f32 v26, v26, v26 quad_perm:[2,3,0,1] row_mask:0xf bank_mask:0xf
    v_mov_b32 v5, v26
    s_nop 1
    v_permlane16_swap_b32 v26, v5
    v_max_f32 v26, v26, v5
    v_mov_b32 v5, v26
    s_nop 1
    v_permlane32_swap_b32 v26, v5
    v_max_f32 v26, v26, v5
    s_mov_b64 exec, 1
    ds_write_b32 v27, v26
    s_mov_b64 exec, -1
    s_waitcnt lgkmcnt(0)
    s_barrier
    ds_read_b128 v[72:75], v28
    ds_read_b128 v[76:79], v28 offset:16
    s_waitcnt lgkmcnt(0)
    v_max3_f32 v26, v72, v73, v74
    v_max3_f32 v5, v75, v76, v77
    v_max3_f32 v26, v26, v78, v79
    v_max_f32 v26, v26, v5
    v_sub_f32 v68, v64, v26
    v_exp_f32 v68, v68
    s_nop 0
    v_cvt_pk_bf16_f32 v68, v68, 0
    v_lshlrev_b32 v69, 16, v68
    v_mul_f32 v29, v69, v66
    v_mov_b32 v32, v68 row_newbcast:0 row_mask:0xf bank_mask:0xf
    v_mov_b32 v33, v68 row_newbcast:1 row_mask:0xf bank_mask:0xf
    v_mov_b32 v34, v68 row_newbcast:2 row_mask:0xf bank_mask:0xf
    v_mov_b32 v35, v68 row_newbcast:3 row_mask:0xf bank_mask:0xf
    v_mov_b32 v36, v69 row_newbcast:0 row_mask:0xf bank_mask:0xf
    v_mov_b32 v37, v69 row_newbcast:1 row_mask:0xf bank_mask:0xf
    v_mov_b32 v38, v69 row_newbcast:2 row_mask:0xf bank_mask:0xf
    v_mov_b32 v39, v69 row_newbcast:3 row_mask:0xf bank_mask:0xf
    v_add_f32 v29, v29, v29 quad_perm:[1,0,3,2] row_mask:0xf bank_mask:0xf
    s_nop 1
    v_add_f32 v29, v29, v29 quad_perm:[2,3,0,1] row_mask:0xf bank_mask:0xf
    v_mov_b32 v5, v29
    s_nop 1
    v_permlane16_swap_b32 v29, v5
    v_add_f32 v29, v29, v5
    v_mov_b32 v5, v29
    s_nop 1
    v_permlane32_swap_b32 v29, v5
    v_add_f32 v29, v29, v5
    v_mov_b32 v31, s79
    s_mov_b64 exec, 1
    ds_write_b32 v27, v29 offset:32
    s_mov_b64 exec, -1
    s_waitcnt vmcnt(3)
    v_dot2_f32_bf16 v80, v48, v32, 0
    v_dot2_f32_bf16 v81, v48, v36, 0
    v_dot2_f32_bf16 v82, v49, v32, 0
    v_dot2_f32_bf16 v83, v49, v36, 0
    v_dot2_f32_bf16 v84, v50, v32, 0
    v_dot2_f32_bf16 v85, v50, v36, 0
    v_dot2_f32_bf16 v86, v51, v32, 0
    v_dot2_f32_bf16 v87, v51, v36, 0
    s_waitcnt vmcnt(2)
    v_dot2_f32_bf16 v80, v52, v33, v80
    v_dot2_f32_bf16 v81, v52, v37, v81
    v_dot2_f32_bf16 v82, v53, v33, v82
    v_dot2_f32_bf16 v83, v53, v37, v83
    v_dot2_f32_bf16 v84, v54, v33, v84
    v_dot2_f32_bf16 v85, v54, v37, v85
    v_dot2_f32_bf16 v86, v55, v33, v86
    v_dot2_f32_bf16 v87, v55, v37, v87
    s_waitcnt vmcnt(1)
    v_dot2_f32_bf16 v80, v56, v34, v80
    v_dot2_f32_bf16 v81, v56, v38, v81
    v_dot2_f32_bf16 v82, v57, v34, v82
    v_dot2_f32_bf16 v83, v57, v38, v83
    v_dot2_f32_bf16 v84, v58, v34, v84
    v_dot2_f32_bf16 v85, v58, v38, v85
    v_dot2_f32_bf16 v86, v59, v34, v86
    v_dot2_f32_bf16 v87, v59, v38, v87
    s_waitcnt vmcnt(0)
    v_dot2_f32_bf16 v80, v60, v35, v80
    v_dot2_f32_bf16 v81, v60, v39, v81
    v_dot2_f32_bf16 v82, v61, v35, v82
    v_dot2_f32_bf16 v83, v61, v39, v83
    v_dot2_f32_bf16 v84, v62, v35, v84
    v_dot2_f32_bf16 v85, v62, v39, v85
    v_dot2_f32_bf16 v86, v63, v35, v86
    v_dot2_f32_bf16 v87, v63, v39, v87
    v_permlane32_swap_b32 v80, v84
    v_permlane32_swap_b32 v81, v85
    v_permlane32_swap_b32 v82, v86
    v_permlane32_swap_b32 v83, v87
    v_pk_add_f32 v[80:81], v[80:81], v[84:85]
    v_pk_add_f32 v[82:83], v[82:83], v[86:87]
    v_cvt_pk_bf16_f32 v80, v80, v81
    v_cvt_pk_bf16_f32 v81, v82, v83
    ds_write_b64 v19, v[80:81]
    s_waitcnt lgkmcnt(0)
    s_barrier
    ds_read_b128 v[48:51], v20 offset:0
    ds_read_b128 v[52:55], v20 offset:64
    ds_read_b128 v[56:59], v20 offset:128
    ds_read_b128 v[60:63], v20 offset:192
    ds_read_b128 v[64:67], v28 offset:32
    ds_read_b128 v[68:71], v28 offset:48
    s_waitcnt lgkmcnt(5)
    v_mfma_f32_16x16x32_bf16 v[80:83], v[48:51], v[132:135], 0
    s_waitcnt lgkmcnt(4)
    v_mfma_f32_16x16x32_bf16 v[80:83], v[52:55], v[136:139], v[80:83]
    s_waitcnt lgkmcnt(3)
    v_mfma_f32_16x16x32_bf16 v[80:83], v[56:59], v[140:143], v[80:83]
    s_waitcnt lgkmcnt(2)
    v_mfma_f32_16x16x32_bf16 v[80:83], v[60:63], v[144:147], v[80:83]
    s_waitcnt lgkmcnt(0)
    v_add_f32 v64, v64, v65
    v_add_f32 v66, v66, v67
    v_add_f32 v68, v68, v69
    v_add_f32 v70, v70, v71
    v_add_f32 v64, v64, v66
    v_add_f32 v68, v68, v70
    v_add_f32 v29, v64, v68
    v_add_f32 v80, v80, v81
    v_add_f32 v82, v82, v83
    v_rcp_f32 v29, v29
    v_mov_b32 v85, s79
    v_add_f32 v80, v80, v82
    v_mov_b32 v8, v80
    s_nop 1
    v_permlane16_swap_b32 v80, v8
    v_add_f32 v80, v80, v8
    v_mov_b32 v8, v80
    s_nop 1
    v_permlane32_swap_b32 v80, v8
    v_add_f32 v80, v80, v8
    s_mov_b64 exec, 0xffff
    v_mul_f32 v84, v80, v29
    buffer_store_dwordx2 v[84:85], v25, s[40:43], s62 offen
    s_mov_b64 exec, -1
    s_cmp_lg_u32 s3, 7
    s_cbranch_scc1 L_w_h4wait
    s_mov_b32 s69, s64
    s_mov_b32 s68, 0
    s_mov_b32 s38, s79
L_w_h4:
    buffer_load_dwordx4 v[48:51], v12, s[40:43], s69 offen sc1
    s_waitcnt vmcnt(0)
    v_xor_b32 v5, s38, v49
    v_xor_b32 v8, s38, v51
    v_mov_b32 v52, v48
    v_mov_b32 v53, v50
    v_or_b32 v5, v5, v8
    v_permlane16_swap_b32 v48, v52
    v_permlane16_swap_b32 v50, v53
    v_cmp_ne_u32 vcc, 0, v5
    v_add_f32 v48, v48, v52
    v_add_f32 v50, v50, v53
    s_cmp_lg_u64 vcc, 0
    s_cbranch_scc0 L_w_h4ok
    s_add_u32 s68, s68, 1
    s_cmp_lt_u32 s68, 48
    s_cbranch_scc1 L_w_h4
    s_cmp_eq_u32 s68, 48
    s_cbranch_scc0 L_w_h4b
    v_mov_b32 v5, 1
    ds_write_b32 v99, v5
    s_waitcnt lgkmcnt(0)
    s_barrier
    v_mov_b32 v85, s29
    s_mov_b64 exec, 0xffff
    buffer_store_dwordx2 v[84:85], v25, s[40:43], s63 offen sc1
    s_mov_b64 exec, -1
    s_barrier
L_w_h4b:
    s_bitcmp1_b32 s68, 0
    s_cselect_b32 s69, s64, s66
    s_cselect_b32 s38, s79, s29
    s_sub_u32 s39, s39, 1
    s_cbranch_scc0 L_w_h4
    s_mov_b32 s39, 0
L_w_h4ok:
    v_mov_b32 v52, v48
    v_mov_b32 v53, v50
    v_mov_b32 v5, 0
    v_permlane32_swap_b32 v48, v52
    v_permlane32_swap_b32 v50, v53
    ds_write_b32 v99, v5
    v_add_f32 v48, v48, v52
    v_add_f32 v50, v50, v53
    v_cvt_pk_bf16_f32 v48, v48, v50
    ds_write_b32 v22, v48
    s_waitcnt lgkmcnt(0)
    s_barrier
    s_lshl_b32 s37, s28, 7
    s_add_u32 s37, s37, 491520
    v_mov_b32 v11, s29
    s_mov_b64 exec, 1
    buffer_store_dword v11, v12, s[40:43], s37 offen sc1
    s_mov_b64 exec, -1
    s_branch L_fin
L_w_h4wait:
    s_barrier
    ds_read_b32 v5, v99
    ds_read_b128 v[148:151], v180
    ds_read_b128 v[152:155], v181
    ds_read_b128 v[156:159], v182
    ds_read_b128 v[160:163], v183
    ds_read_b128 v[164:167], v184
    ds_read_b128 v[168:171], v185
    ds_read_b128 v[172:175], v186
    ds_read_b128 v[176:179], v187
    s_mov_b64 exec, -1
    s_waitcnt lgkmcnt(8)
    v_cmp_ne_u32 vcc, 0, v5
    s_cbranch_vccz L_w_h4go
    v_mov_b32 v85, s29
    s_mov_b64 exec, 0xffff
    buffer_store_dwordx2 v[84:85], v25, s[40:43], s63 offen sc1
    s_mov_b64 exec, -1
    s_waitcnt lgkmcnt(0)
    s_barrier
    s_branch L_w_h4wait
L_w_h4go:
    s_cmp_ge_u32 s3, 5
    s_cbranch_scc1 L_w_o_skip
    s_waitcnt lgkmcnt(7)
    v_mfma_f32_16x16x32_bf16 v[88:91], v[100:103], v[148:151], 0
    s_waitcnt lgkmcnt(6)
    v_mfma_f32_16x16x32_bf16 v[88:91], v[104:107], v[152:155], v[88:91]
    s_waitcnt lgkmcnt(5)
    v_mfma_f32_16x16x32_bf16 v[88:91], v[108:111], v[156:159], v[88:91]
    s_waitcnt lgkmcnt(4)
    v_mfma_f32_16x16x32_bf16 v[88:91], v[112:115], v[160:163], v[88:91]
    s_waitcnt lgkmcnt(3)
    v_mfma_f32_16x16x32_bf16 v[88:91], v[116:119], v[164:167], v[88:91]
    s_waitcnt lgkmcnt(2)
    v_mfma_f32_16x16x32_bf16 v[88:91], v[120:123], v[168:171], v[88:91]
    s_waitcnt lgkmcnt(1)
    v_mfma_f32_16x16x32_bf16 v[88:91], v[124:127], v[172:175], v[88:91]
    s_waitcnt lgkmcnt(0)
    v_mfma_f32_16x16x32_bf16 v[88:91], v[128:131], v[176:179], v[88:91]
    s_mov_b32 vcc_lo, 0xaaaaaaaa
    s_mov_b32 vcc_hi, 0xaaaaaaaa
    v_mov_b32 v49, s29
    v_mov_b32 v51, s29
    s_nop 3
    v_cndmask_b32 v48, v88, v90, vcc
    v_cndmask_b32 v50, v89, v91, vcc
    buffer_store_dwordx4 v[48:51], v21, s[40:43], s35 offen sc1
L_w_o_skip:
    s_branch L_fin
    .p2align 3
L_KV:
    s_lshl_b32 s33, s3, 12
    s_lshl_b32 s66, s28, 17
    s_add_u32 s66, s66, s33
    s_mul_i32 s67, s3, 4224
    s_add_u32 s64, s33, 262144
    s_lshl_b32 s65, s3, 11
    s_add_u32 s65, s65, 4096
    s_add_u32 s38, s33, 33792
    s_lshl_b32 s37, s31, 7
    s_lshl_b32 s32, s3, 4
    s_add_u32 s37, s37, s32
    s_lshl_b32 s37, s37, 13
    s_lshl_b32 s32, s30, 8
    s_add_u32 s89, s37, s32
    v_lshrrev_b32 v240, 1, v1
    v_lshlrev_b32 v240, 13, v240
    v_and_b32 v241, 1, v1
    v_lshl_add_u32 v240, v241, 7, v240
    s_waitcnt lgkmcnt(0)
    s_load_dword s29, s[26:27], 0
    s_mov_b32 s40, s26
    s_and_b32 s41, s27, 0xffff
    s_mov_b32 s44, s6
    s_and_b32 s45, s7, 0xffff
    s_mov_b32 s46, 16777216
    s_cmp_eq_u32 s3, 5
    s_cbranch_scc0 L_k_not_ln
    s_mov_b32 s52, s4
    s_and_b32 s53, s5, 0xffff
    s_mov_b32 s54, 1280
    v_lshlrev_b32 v4, 2, v1
    buffer_load_dword v232, v4, s[52:55], 0 offen offset:0
    buffer_load_dword v233, v4, s[52:55], 0 offen offset:256
    buffer_load_dword v234, v4, s[52:55], 0 offen offset:512
    buffer_load_dword v235, v4, s[52:55], 0 offen offset:768
    buffer_load_dword v236, v4, s[52:55], 0 offen offset:1024
L_k_not_ln:
    s_mov_b32 s48, s10
    s_and_b32 s49, s11, 0xffff
    s_mov_b32 s50, 4194304
    s_waitcnt vmcnt(0)
    s_barrier
    s_mov_b32 exec_hi, 0
    buffer_load_dword v209, v240, s[48:51], s89 offen
    s_mov_b32 exec_hi, -1
    s_barrier
    s_add_u32 m0, s67, 0
    s_add_u32 s33, s66, 0
    buffer_load_dwordx4 v12, s[44:47], s33 offen lds
    s_add_u32 m0, s67, 1056
    s_add_u32 s33, s66, 1024
    buffer_load_dwordx4 v12, s[44:47], s33 offen lds
    s_add_u32 m0, s67, 2112
    s_add_u32 s33, s66, 2048
    buffer_load_dwordx4 v12, s[44:47], s33 offen lds
    s_add_u32 m0, s67, 3168
    s_add_u32 s33, s66, 3072
    buffer_load_dwordx4 v12, s[44:47], s33 offen lds
    s_barrier
    s_add_u32 m0, s67, 33792
    s_add_u32 s33, s66, 32768
    buffer_load_dwordx4 v12, s[44:47], s33 offen lds
    s_add_u32 m0, s67, 34848
    s_add_u32 s33, s66, 33792
    buffer_load_dwordx4 v12, s[44:47], s33 offen lds
    s_add_u32 m0, s67, 35904
    s_add_u32 s33, s66, 34816
    buffer_load_dwordx4 v12, s[44:47], s33 offen lds
    s_add_u32 m0, s67, 36960
    s_add_u32 s33, s66, 35840
    buffer_load_dwordx4 v12, s[44:47], s33 offen lds
    s_lshr_b32 s34, s3, 1
    s_and_b32 s35, s3, 1
    v_lshrrev_b32 v15, 3, v1
    v_lshlrev_b32 v11, 17, v15
    v_and_b32 v240, 7, v1
    v_lshl_add_u32 v11, v240, 4, v11
    v_xor_b32 v241, v240, v15
    v_lshlrev_b32 v241, 4, v241
    v_lshl_add_u32 v10, v15, 7, v241
    v_add_u32 v10, s38, v10
    v_and_b32 v240, 7, v2
    v_and_b32 v242, 1, v3
    v_lshlrev_b32 v242, 1, v242
    v_lshrrev_b32 v241, 1, v3
    v_add_u32 v242, v242, v241
    v_xor_b32 v242, v242, v240
    v_lshlrev_b32 v242, 4, v242
    v_lshl_add_u32 v4, v2, 7, v242
    v_add_u32 v4, s38, v4
    v_xor_b32 v5, 64, v4
    s_lshl_b32 s32, s34, 15
    s_lshl_b32 s33, s28, 8
    s_add_u32 s60, s32, s33
    s_lshl_b32 s33, s35, 7
    s_add_u32 s60, s60, s33
    s_add_u32 s60, s60, 2097152
    s_add_u32 s61, s60, 1048576
    s_add_u32 s62, s61, 1048576
    s_add_u32 s63, s62, 1048576
    s_lshl_b32 s69, s28, 3
    s_add_u32 s69, s69, 1835008
    v_mul_u32_u24 v15, 0x420, v2
    v_lshl_add_u32 v15, v3, 4, v15
    s_lshr_b32 s32, s3, 2
    s_mul_i32 s33, s32, 67584
    s_and_b32 s36, s34, 1
    s_mul_i32 s37, s36, 16896
    s_add_u32 s33, s33, s37
    v_add_u32 v249, s33, v15
    s_mul_i32 s33, s35, 16896
    v_add_u32 v6, s33, v15
    v_lshrrev_b32 v15, 2, v2
    v_lshl_add_u32 v15, v3, 2, v15
    v_mul_u32_u24 v252, 0x420, v15
    v_and_b32 v15, 3, v2
    v_lshl_add_u32 v252, v15, 3, v252
    s_lshl_b32 s33, s3, 7
    v_add_u32 v252, s33, v252
    v_add_u32 v254, 67584, v252
    v_mul_u32_u24 v9, 80, v2
    v_lshl_add_u32 v9, v3, 4, v9
    v_add_u32 v9, 135168, v9
    s_mul_i32 s33, s32, 5120
    s_mul_i32 s37, s35, 1280
    s_add_u32 s33, s33, s37
    s_lshl_b32 s37, s36, 3
    s_add_u32 s33, s33, s37
    v_add_u32 v8, s33, v9
    s_lshl_b32 s33, s35, 9
    s_add_u32 s33, s33, 145408
    v_lshl_add_u32 v253, v2, 5, s33
    s_lshl_b32 s33, s34, 2
    v_add_u32 v7, s33, v253
    v_add_u32 v250, s67, v12
    v_lshlrev_b32 v248, 7, v2
    v_mov_b32 v251, 147456
    v_mov_b32 v15, 0
    ds_write_b32 v251, v15
    s_mov_b32 s52, s18
    s_and_b32 s53, s19, 0xffff
    s_mov_b32 s54, 2211840
    s_mov_b32 s56, s20
    s_and_b32 s57, s21, 0xffff
    s_mov_b32 s58, 2211840
    s_mul_i32 s74, s3, 110592
    s_lshl_b32 s37, s28, 5
    s_add_u32 s74, s74, s37
    s_lshl_b32 s75, s3, 10
    s_mul_i32 s76, s28, 20480
    s_add_u32 s76, s76, s75
    s_add_u32 s77, s75, 88064
    s_add_u32 s78, s75, 96256
    s_add_u32 s79, s75, 148736
    s_cmp_lt_u32 s3, 2
    s_cselect_b32 s78, s78, s79
    s_add_u32 s79, s75, 156928
    s_and_b32 s37, s3, 3
    s_mul_i32 s37, s37, 40
    v_min_u32 v247, 39, v1
    v_add_u32 v247, s37, v247
    s_mul_i32 s88, s31, 552960
    s_lshl_b32 s37, s30, 7
    s_add_u32 s88, s88, s37
    s_mul_i32 s37, s28, 20480
    s_cmp_ge_u32 s3, 4
    s_cselect_b32 s88, s37, s88
    s_cselect_b32 s37, 1, 27
    s_lshl_b32 s37, s37, 7
    v_mul_lo_u32 v247, v247, s37
    s_lshl_b32 s90, s28, 7
    s_add_u32 s91, s90, 458752
    s_add_u32 s90, s90, 475136
    s_waitcnt lgkmcnt(0)
    s_add_u32 s29, s29, 1
    s_waitcnt vmcnt(4)
    s_barrier
    s_mov_b64 exec, 0xffff
    buffer_load_dword v0, v248, s[40:43], s65 offen sc1
    s_mov_b64 exec, -1
    s_add_u32 m0, s67, 67584
    s_add_u32 s33, s66, 65536
    buffer_load_dwordx4 v12, s[44:47], s33 offen lds
    s_add_u32 m0, s67, 68640
    s_add_u32 s33, s66, 66560
    buffer_load_dwordx4 v12, s[44:47], s33 offen lds
    s_add_u32 m0, s67, 69696
    s_add_u32 s33, s66, 67584
    buffer_load_dwordx4 v12, s[44:47], s33 offen lds
    s_add_u32 m0, s67, 70752
    s_add_u32 s33, s66, 68608
    buffer_load_dwordx4 v12, s[44:47], s33 offen lds
    ds_read_b64_tr_b16 v[144:145], v252 offset:0
    ds_read_b64_tr_b16 v[146:147], v252 offset:16896
    ds_read_b64_tr_b16 v[148:149], v252 offset:32
    ds_read_b64_tr_b16 v[150:151], v252 offset:16928
    ds_read_b64_tr_b16 v[152:153], v252 offset:64
    ds_read_b64_tr_b16 v[154:155], v252 offset:16960
    ds_read_b64_tr_b16 v[156:157], v252 offset:96
    ds_read_b64_tr_b16 v[158:159], v252 offset:16992
    s_cmp_ge_u32 s3, 4
    s_cbranch_scc1 L_k_p0
    s_waitcnt lgkmcnt(4)
    ds_read_b128 v[16:19], v249 offset:0
    ds_read_b128 v[20:23], v249 offset:64
    ds_read_b128 v[24:27], v249 offset:128
    ds_read_b128 v[28:31], v249 offset:192
    ds_read_b128 v[32:35], v249 offset:256
    ds_read_b128 v[36:39], v249 offset:320
    ds_read_b128 v[40:43], v249 offset:384
    ds_read_b128 v[44:47], v249 offset:448
    s_waitcnt lgkmcnt(4)
    ds_read_b128 v[48:51], v249 offset:512
    ds_read_b128 v[52:55], v249 offset:576
    ds_read_b128 v[56:59], v249 offset:640
    ds_read_b128 v[60:63], v249 offset:704
    ds_read_b128 v[64:67], v249 offset:768
    ds_read_b128 v[68:71], v249 offset:832
    ds_read_b128 v[72:75], v249 offset:896
    ds_read_b128 v[76:79], v249 offset:960
L_k_p0:
    s_cmp_eq_u32 s3, 5
    s_cbranch_scc0 L_k_ln_done
    v_and_b32 v32, 0x31, v1
    v_and_b32 v33, 6, v1
    v_lshl_or_b32 v32, v33, 1, v32
    v_bfe_u32 v33, v1, 3, 1
    v_lshl_or_b32 v32, v33, 1, v32
    v_lshlrev_b32 v32, 2, v32
    v_add_u32 v32, 147520, v32
    s_nop 0
    v_readfirstlane_b32 s37, v232
    s_nop 0
    s_lshl_b32 s37, s37, 16
    v_lshlrev_b32 v16, 16, v232
    v_and_b32 v17, 0xffff0000, v232
    v_lshlrev_b32 v18, 16, v233
    v_and_b32 v19, 0xffff0000, v233
    v_lshlrev_b32 v20, 16, v234
    v_and_b32 v21, 0xffff0000, v234
    v_lshlrev_b32 v22, 16, v235
    v_and_b32 v23, 0xffff0000, v235
    v_lshlrev_b32 v24, 16, v236
    v_and_b32 v25, 0xffff0000, v236
    v_subrev_f32 v16, s37, v16
    v_subrev_f32 v17, s37, v17
    v_subrev_f32 v18, s37, v18
    v_subrev_f32 v19, s37, v19
    v_subrev_f32 v20, s37, v20
    v_subrev_f32 v21, s37, v21
    v_subrev_f32 v22, s37, v22
    v_subrev_f32 v23, s37, v23
    v_subrev_f32 v24, s37, v24
    v_subrev_f32 v25, s37, v25
    v_pk_add_f32 v[26:27], v[16:17], v[18:19]
    v_pk_mul_f32 v[28:29], v[16:17], v[16:17]
    v_pk_fma_f32 v[28:29], v[18:19], v[18:19], v[28:29]
    v_pk_add_f32 v[26:27], v[26:27], v[20:21]
    v_pk_fma_f32 v[28:29], v[20:21], v[20:21], v[28:29]
    v_pk_add_f32 v[26:27], v[26:27], v[22:23]
    v_pk_fma_f32 v[28:29], v[22:23], v[22:23], v[28:29]
    v_pk_add_f32 v[26:27], v[26:27], v[24:25]
    v_pk_fma_f32 v[28:29], v[24:25], v[24:25], v[28:29]
    v_add_f32 v26, v26, v27
    v_add_f32 v28, v28, v29
    s_nop 0
    v_add_f32 v26, v26, v26 row_ror:8 row_mask:0xf bank_mask:0xf
    v_add_f32 v28, v28, v28 row_ror:8 row_mask:0xf bank_mask:0xf
    s_nop 0
    v_add_f32 v26, v26, v26 row_ror:4 row_mask:0xf bank_mask:0xf
    v_add_f32 v28, v28, v28 row_ror:4 row_mask:0xf bank_mask:0xf
    s_nop 0
    v_add_f32 v26, v26, v26 row_ror:2 row_mask:0xf bank_mask:0xf
    v_add_f32 v28, v28, v28 row_ror:2 row_mask:0xf bank_mask:0xf
    s_nop 0
    v_add_f32 v26, v26, v26 row_ror:1 row_mask:0xf bank_mask:0xf
    v_add_f32 v28, v28, v28 row_ror:1 row_mask:0xf bank_mask:0xf
    v_mov_b32 v27, v26
    v_mov_b32 v29, v28
    s_nop 0
    v_permlane16_swap_b32 v26, v27
    v_permlane16_swap_b32 v28, v29
    v_add_f32 v26, v26, v27
    v_add_f32 v28, v28, v29
    v_mov_b32 v27, v26
    v_mov_b32 v29, v28
    s_nop 0
    v_permlane32_swap_b32 v26, v27
    v_permlane32_swap_b32 v28, v29
    v_add_f32 v26, v26, v27
    v_add_f32 v28, v28, v29
    v_mul_f32 v26, 0x3acccccd, v26
    v_mul_f32 v28, 0x3acccccd, v28
    v_fma_f32 v28, -v26, v26, v28
    v_max_f32 v28, 0, v28
    v_add_f32 v26, s37, v26
    v_cvt_pk_bf16_f32 v26, v26, v28
    v_and_b32 v28, 0xffff0000, v26
    v_lshlrev_b32 v26, 16, v26
    v_add_f32 v28, 0x3727c5ac, v28
    v_cvt_pk_bf16_f32 v28, v28, v28
    v_and_b32 v28, 0xffff0000, v28
    v_sqrt_f32 v28, v28
    s_nop 0
    v_cvt_pk_bf16_f32 v28, v28, v28
    v_and_b32 v28, 0xffff0000, v28
    v_lshlrev_b32 v16, 16, v232
    v_and_b32 v17, 0xffff0000, v232
    v_lshlrev_b32 v18, 16, v233
    v_and_b32 v19, 0xffff0000, v233
    v_lshlrev_b32 v20, 16, v234
    v_and_b32 v21, 0xffff0000, v234
    v_lshlrev_b32 v22, 16, v235
    v_and_b32 v23, 0xffff0000, v235
    v_lshlrev_b32 v24, 16, v236
    v_and_b32 v25, 0xffff0000, v236
    v_rcp_f32 v30, v28
    v_sub_f32 v16, v16, v26
    v_sub_f32 v17, v17, v26
    v_sub_f32 v18, v18, v26
    v_sub_f32 v19, v19, v26
    v_sub_f32 v20, v20, v26
    v_sub_f32 v21, v21, v26
    v_sub_f32 v22, v22, v26
    v_sub_f32 v23, v23, v26
    v_sub_f32 v24, v24, v26
    v_sub_f32 v25, v25, v26
    v_fma_f32 v31, -v28, v30, 1.0
    v_fma_f32 v30, v31, v30, v30
    v_cvt_pk_bf16_f32 v232, v16, v17
    v_cvt_pk_bf16_f32 v233, v18, v19
    v_cvt_pk_bf16_f32 v234, v20, v21
    v_cvt_pk_bf16_f32 v235, v22, v23
    v_cvt_pk_bf16_f32 v236, v24, v25
    v_lshlrev_b32 v16, 16, v232
    v_and_b32 v17, 0xffff0000, v232
    v_lshlrev_b32 v18, 16, v233
    v_and_b32 v19, 0xffff0000, v233
    v_lshlrev_b32 v20, 16, v234
    v_and_b32 v21, 0xffff0000, v234
    v_lshlrev_b32 v22, 16, v235
    v_and_b32 v23, 0xffff0000, v235
    v_lshlrev_b32 v24, 16, v236
    v_and_b32 v25, 0xffff0000, v236
    v_mul_f32 v26, v16, v30
    v_mul_f32 v27, v17, v30
    v_fma_f32 v16, -v26, v28, v16
    v_fma_f32 v17, -v27, v28, v17
    v_fma_f32 v16, v16, v30, v26
    v_fma_f32 v17, v17, v30, v27
    v_cvt_pk_bf16_f32 v232, v16, v17
    ds_write_b32 v32, v232 offset:0
    v_mul_f32 v26, v18, v30
    v_mul_f32 v27, v19, v30
    v_fma_f32 v18, -v26, v28, v18
    v_fma_f32 v19, -v27, v28, v19
    v_fma_f32 v18, v18, v30, v26
    v_fma_f32 v19, v19, v30, v27
    v_cvt_pk_bf16_f32 v233, v18, v19
    ds_write_b32 v32, v233 offset:256
    v_mul_f32 v26, v20, v30
    v_mul_f32 v27, v21, v30
    v_fma_f32 v20, -v26, v28, v20
    v_fma_f32 v21, -v27, v28, v21
    v_fma_f32 v20, v20, v30, v26
    v_fma_f32 v21, v21, v30, v27
    v_cvt_pk_bf16_f32 v234, v20, v21
    ds_write_b32 v32, v234 offset:512
    v_mul_f32 v26, v22, v30
    v_mul_f32 v27, v23, v30
    v_fma_f32 v22, -v26, v28, v22
    v_fma_f32 v23, -v27, v28, v23
    v_fma_f32 v22, v22, v30, v26
    v_fma_f32 v23, v23, v30, v27
    v_cvt_pk_bf16_f32 v235, v22, v23
    ds_write_b32 v32, v235 offset:768
    v_mul_f32 v26, v24, v30
    v_mul_f32 v27, v25, v30
    v_fma_f32 v24, -v26, v28, v24
    v_fma_f32 v25, -v27, v28, v25
    v_fma_f32 v24, v24, v30, v26
    v_fma_f32 v25, v25, v30, v27
    v_cvt_pk_bf16_f32 v236, v24, v25
    ds_write_b32 v32, v236 offset:1024
L_k_ln_done:
    s_waitcnt vmcnt(5)
    s_barrier
    s_waitcnt lgkmcnt(4)
    ds_read_b64_tr_b16 v[160:161], v252 offset:33792
    ds_read_b64_tr_b16 v[162:163], v252 offset:50688
    ds_read_b64_tr_b16 v[164:165], v252 offset:33824
    ds_read_b64_tr_b16 v[166:167], v252 offset:50720
    ds_read_b64_tr_b16 v[168:169], v252 offset:33856
    ds_read_b64_tr_b16 v[170:171], v252 offset:50752
    ds_read_b64_tr_b16 v[172:173], v252 offset:33888
    ds_read_b64_tr_b16 v[174:175], v252 offset:50784
    s_cmp_ge_u32 s3, 4
    s_cbranch_scc1 L_k_p1
    s_waitcnt lgkmcnt(4)
    ds_read_b128 v[80:83], v249 offset:33792
    ds_read_b128 v[84:87], v249 offset:33856
    ds_read_b128 v[88:91], v249 offset:33920
    ds_read_b128 v[92:95], v249 offset:33984
    ds_read_b128 v[96:99], v249 offset:34048
    ds_read_b128 v[100:103], v249 offset:34112
    ds_read_b128 v[104:107], v249 offset:34176
    ds_read_b128 v[108:111], v249 offset:34240
    s_waitcnt lgkmcnt(4)
    ds_read_b128 v[112:115], v249 offset:34304
    ds_read_b128 v[116:119], v249 offset:34368
    ds_read_b128 v[120:123], v249 offset:34432
    ds_read_b128 v[124:127], v249 offset:34496
    ds_read_b128 v[128:131], v249 offset:34560
    ds_read_b128 v[132:135], v249 offset:34624
    ds_read_b128 v[136:139], v249 offset:34688
    ds_read_b128 v[140:143], v249 offset:34752
L_k_p1:
    s_waitcnt vmcnt(3)
    s_mov_b64 exec, 0xffff
L_k_fl:
    v_cmp_ne_u32 vcc, s29, v0
    s_nop 0
    s_cmp_lg_u64 vcc, 0
    s_cbranch_scc0 L_k_flok
    buffer_load_dword v0, v248, s[40:43], s65 offen sc1
    s_waitcnt vmcnt(0)
    s_cbranch_scc0 L_k_flok
    s_sub_u32 s39, s39, 1
    s_cbranch_scc0 L_k_fl
    s_mov_b32 s39, 0
L_k_flok:
    s_mov_b64 exec, -1
    buffer_load_dwordx4 v[208:211], v12, s[40:43], s64 offen offset:0 sc1
    buffer_load_dwordx4 v[212:215], v12, s[40:43], s64 offen offset:1024 sc1
    buffer_load_dwordx4 v[216:219], v12, s[40:43], s64 offen offset:2048 sc1
    buffer_load_dwordx4 v[220:223], v12, s[40:43], s64 offen offset:3072 sc1
    s_waitcnt vmcnt(4) lgkmcnt(0)
    s_barrier
    ds_read_b64_tr_b16 v[176:177], v254 offset:0
    ds_read_b64_tr_b16 v[178:179], v254 offset:16896
    ds_read_b64_tr_b16 v[180:181], v254 offset:32
    ds_read_b64_tr_b16 v[182:183], v254 offset:16928
    ds_read_b64_tr_b16 v[184:185], v254 offset:64
    ds_read_b64_tr_b16 v[186:187], v254 offset:16960
    ds_read_b64_tr_b16 v[188:189], v254 offset:96
    ds_read_b64_tr_b16 v[190:191], v254 offset:16992
    s_cmp_lt_u32 s3, 4
    s_cbranch_scc1 L_k_p2
    s_waitcnt lgkmcnt(4)
    ds_read_b128 v[16:19], v249 offset:0
    ds_read_b128 v[20:23], v249 offset:64
    ds_read_b128 v[24:27], v249 offset:128
    ds_read_b128 v[28:31], v249 offset:192
    ds_read_b128 v[32:35], v249 offset:256
    ds_read_b128 v[36:39], v249 offset:320
    ds_read_b128 v[40:43], v249 offset:384
    ds_read_b128 v[44:47], v249 offset:448
    s_waitcnt lgkmcnt(4)
    ds_read_b128 v[48:51], v249 offset:512
    ds_read_b128 v[52:55], v249 offset:576
    ds_read_b128 v[56:59], v249 offset:640
    ds_read_b128 v[60:63], v249 offset:704
    ds_read_b128 v[64:67], v249 offset:768
    ds_read_b128 v[68:71], v249 offset:832
    ds_read_b128 v[72:75], v249 offset:896
    ds_read_b128 v[76:79], v249 offset:960
L_k_p2:
    s_waitcnt vmcnt(0)
L_k_q:
    v_max3_u32 v15, v208, v209, v210
    v_max3_u32 v240, v211, v212, v213
    v_max3_u32 v241, v214, v215, v216
    v_max3_u32 v242, v217, v218, v219
    v_max3_u32 v243, v220, v221, v222
    v_max3_u32 v15, v15, v240, v223
    v_max3_u32 v241, v241, v242, v243
    v_max_u32 v15, v15, v241
    v_cmp_eq_u32 vcc, -1, v15
    s_nop 0
    s_cmp_lg_u64 vcc, 0
    s_cbranch_scc0 L_k_qok
    s_mov_b64 exec, vcc
    buffer_load_dwordx4 v[208:211], v12, s[40:43], s64 offen offset:0 sc1
    buffer_load_dwordx4 v[212:215], v12, s[40:43], s64 offen offset:1024 sc1
    buffer_load_dwordx4 v[216:219], v12, s[40:43], s64 offen offset:2048 sc1
    buffer_load_dwordx4 v[220:223], v12, s[40:43], s64 offen offset:3072 sc1
    s_mov_b64 exec, -1
    s_waitcnt vmcnt(0)
    s_cbranch_scc0 L_k_qok
    s_sub_u32 s39, s39, 1
    s_cbranch_scc0 L_k_q
    s_mov_b32 s39, 0
L_k_qok:
    s_waitcnt lgkmcnt(8)
    ds_write_b128 v250, v[208:211] offset:0
    ds_write_b128 v250, v[212:215] offset:1056
    ds_write_b128 v250, v[216:219] offset:2112
    ds_write_b128 v250, v[220:223] offset:3168
    s_add_u32 m0, s67, 101376
    s_add_u32 s33, s66, 98304
    buffer_load_dwordx4 v12, s[44:47], s33 offen lds
    s_add_u32 m0, s67, 102432
    s_add_u32 s33, s66, 99328
    buffer_load_dwordx4 v12, s[44:47], s33 offen lds
    s_add_u32 m0, s67, 103488
    s_add_u32 s33, s66, 100352
    buffer_load_dwordx4 v12, s[44:47], s33 offen lds
    s_add_u32 m0, s67, 104544
    s_add_u32 s33, s66, 101376
    buffer_load_dwordx4 v12, s[44:47], s33 offen lds
    s_waitcnt lgkmcnt(0)
    s_barrier
    s_cmp_ge_u32 s3, 4
    s_cbranch_scc1 L_k_late
    .p2align 3
    ds_read_b128 v[208:211], v6 offset:0
    ds_read_b128 v[212:215], v6 offset:64
    ds_read_b128 v[216:219], v6 offset:128
    ds_read_b128 v[220:223], v6 offset:192
    ds_read_b128 v[224:227], v6 offset:256
    s_waitcnt lgkmcnt(4)
    v_mfma_f32_16x16x32_bf16 v[232:235], v[16:19], v[208:211], 0
    v_mfma_f32_16x16x32_bf16 v[236:239], v[80:83], v[208:211], 0
    ds_read_b128 v[228:231], v6 offset:320
    s_waitcnt lgkmcnt(4)
    v_mfma_f32_16x16x32_bf16 v[232:235], v[20:23], v[212:215], v[232:235]
    v_mfma_f32_16x16x32_bf16 v[236:239], v[84:87], v[212:215], v[236:239]
    ds_read_b128 v[208:211], v6 offset:384
    s_waitcnt lgkmcnt(4)
    v_mfma_f32_16x16x32_bf16 v[232:235], v[24:27], v[216:219], v[232:235]
    v_mfma_f32_16x16x32_bf16 v[236:239], v[88:91], v[216:219], v[236:239]
    ds_read_b128 v[212:215], v6 offset:448
    s_waitcnt lgkmcnt(4)
    v_mfma_f32_16x16x32_bf16 v[232:235], v[28:31], v[220:223], v[232:235]
    v_mfma_f32_16x16x32_bf16 v[236:239], v[92:95], v[220:223], v[236:239]
    ds_read_b128 v[216:219], v6 offset:512
    s_waitcnt lgkmcnt(4)
    v_mfma_f32_16x16x32_bf16 v[232:235], v[32:35], v[224:227], v[232:235]
    v_mfma_f32_16x16x32_bf16 v[236:239], v[96:99], v[224:227], v[236:239]
    ds_read_b128 v[220:223], v6 offset:576
    s_waitcnt lgkmcnt(4)
    v_mfma_f32_16x16x32_bf16 v[232:235], v[36:39], v[228:231], v[232:235]
    v_mfma_f32_16x16x32_bf16 v[236:239], v[100:103], v[228:231], v[236:239]
    ds_read_b128 v[224:227], v6 offset:640
    s_waitcnt lgkmcnt(4)
    v_mfma_f32_16x16x32_bf16 v[232:235], v[40:43], v[208:211], v[232:235]
    v_mfma_f32_16x16x32_bf16 v[236:239], v[104:107], v[208:211], v[236:239]
    ds_read_b128 v[228:231], v6 offset:704
    s_waitcnt lgkmcnt(4)
    v_mfma_f32_16x16x32_bf16 v[232:235], v[44:47], v[212:215], v[232:235]
    v_mfma_f32_16x16x32_bf16 v[236:239], v[108:111], v[212:215], v[236:239]
    ds_read_b128 v[208:211], v6 offset:768
    s_waitcnt lgkmcnt(4)
    v_mfma_f32_16x16x32_bf16 v[232:235], v[48:51], v[216:219], v[232:235]
    v_mfma_f32_16x16x32_bf16 v[236:239], v[112:115], v[216:219], v[236:239]
    ds_read_b128 v[212:215], v6 offset:832
    s_waitcnt lgkmcnt(4)
    v_mfma_f32_16x16x32_bf16 v[232:235], v[52:55], v[220:223], v[232:235]
    v_mfma_f32_16x16x32_bf16 v[236:239], v[116:119], v[220:223], v[236:239]
    ds_read_b128 v[216:219], v6 offset:896
    s_waitcnt lgkmcnt(4)
    v_mfma_f32_16x16x32_bf16 v[232:235], v[56:59], v[224:227], v[232:235]
    v_mfma_f32_16x16x32_bf16 v[236:239], v[120:123], v[224:227], v[236:239]
    ds_read_b128 v[220:223], v6 offset:960
    s_waitcnt lgkmcnt(4)
    v_mfma_f32_16x16x32_bf16 v[232:235], v[60:63], v[228:231], v[232:235]
    v_mfma_f32_16x16x32_bf16 v[236:239], v[124:127], v[228:231], v[236:239]
    s_waitcnt lgkmcnt(3)
    v_mfma_f32_16x16x32_bf16 v[232:235], v[64:67], v[208:211], v[232:235]
    v_mfma_f32_16x16x32_bf16 v[236:239], v[128:131], v[208:211], v[236:239]
    s_waitcnt lgkmcnt(2)
    v_mfma_f32_16x16x32_bf16 v[232:235], v[68:71], v[212:215], v[232:235]
    v_mfma_f32_16x16x32_bf16 v[236:239], v[132:135], v[212:215], v[236:239]
    s_waitcnt lgkmcnt(1)
    v_mfma_f32_16x16x32_bf16 v[232:235], v[72:75], v[216:219], v[232:235]
    v_mfma_f32_16x16x32_bf16 v[236:239], v[136:139], v[216:219], v[236:239]
    s_waitcnt lgkmcnt(0)
    v_mfma_f32_16x16x32_bf16 v[232:235], v[76:79], v[220:223], v[232:235]
    v_mfma_f32_16x16x32_bf16 v[236:239], v[140:143], v[220:223], v[236:239]
    s_nop 6
    v_max3_f32 v246, v232, v233, v234
    v_max3_f32 v15, v235, v236, v237
    v_max3_f32 v246, v246, v238, v239
    v_max_f32 v246, v246, v15
    v_mov_b32 v15, v246
    s_nop 1
    v_permlane16_swap_b32 v246, v15
    v_max_f32 v246, v246, v15
    v_mov_b32 v15, v246
    s_nop 1
    v_permlane32_swap_b32 v246, v15
    v_max_f32 v246, v246, v15
    ds_write_b32 v7, v246
    s_waitcnt lgkmcnt(0)
    s_barrier
    ds_read_b64 v[240:241], v253
    buffer_load_dword v247, v247, s[52:55], s88 offen
    v_mov_b32 v112, 0x3f803f80
    v_mov_b32 v113, 0x3f803f80
    v_mov_b32 v114, 0x3f803f80
    v_mov_b32 v115, 0x3f803f80
    s_waitcnt lgkmcnt(0)
    v_max_f32 v246, v240, v241
    v_ceil_f32 v13, v246
    v_sub_f32 v208, v232, v13
    v_sub_f32 v209, v233, v13
    v_sub_f32 v210, v234, v13
    v_sub_f32 v211, v235, v13
    v_sub_f32 v216, v236, v13
    v_sub_f32 v217, v237, v13
    v_sub_f32 v218, v238, v13
    v_sub_f32 v219, v239, v13
    v_exp_f32 v208, v208
    v_exp_f32 v209, v209
    v_exp_f32 v210, v210
    v_exp_f32 v211, v211
    v_exp_f32 v216, v216
    v_exp_f32 v217, v217
    v_exp_f32 v218, v218
    v_exp_f32 v219, v219
    v_cvt_pk_bf16_f32 v212, v208, v209
    v_cvt_pk_bf16_f32 v213, v210, v211
    ds_write_b64 v8, v[212:213] offset:0
    v_cvt_pk_bf16_f32 v220, v216, v217
    v_cvt_pk_bf16_f32 v221, v218, v219
    ds_write_b64 v8, v[220:221] offset:2560
    s_waitcnt vmcnt(1) lgkmcnt(0)
    s_barrier
    ds_read_b128 v[48:51], v9 offset:0
    ds_read_b128 v[52:55], v9 offset:1280
    ds_read_b128 v[56:59], v9 offset:2560
    ds_read_b128 v[60:63], v9 offset:3840
    ds_read_b64_tr_b16 v[192:193], v254 offset:33792
    ds_read_b64_tr_b16 v[194:195], v254 offset:50688
    ds_read_b64_tr_b16 v[196:197], v254 offset:33824
    ds_read_b64_tr_b16 v[198:199], v254 offset:50720
    ds_read_b64_tr_b16 v[200:201], v254 offset:33856
    ds_read_b64_tr_b16 v[202:203], v254 offset:50752
    ds_read_b64_tr_b16 v[204:205], v254 offset:33888
    ds_read_b64_tr_b16 v[206:207], v254 offset:50784
    s_waitcnt lgkmcnt(10)
    v_mfma_f32_16x16x32_bf16 v[16:19], v[144:147], v[48:51], 0
    v_mfma_f32_16x16x32_bf16 v[32:35], v[144:147], v[52:55], 0
    v_mfma_f32_16x16x32_bf16 v[20:23], v[148:151], v[48:51], 0
    v_mfma_f32_16x16x32_bf16 v[36:39], v[148:151], v[52:55], 0
    v_mfma_f32_16x16x32_bf16 v[24:27], v[152:155], v[48:51], 0
    v_mfma_f32_16x16x32_bf16 v[40:43], v[152:155], v[52:55], 0
    v_mfma_f32_16x16x32_bf16 v[28:31], v[156:159], v[48:51], 0
    v_mfma_f32_16x16x32_bf16 v[44:47], v[156:159], v[52:55], 0
    s_waitcnt lgkmcnt(8)
    v_mfma_f32_16x16x32_bf16 v[16:19], v[160:163], v[56:59], v[16:19]
    v_mfma_f32_16x16x32_bf16 v[32:35], v[160:163], v[60:63], v[32:35]
    v_mfma_f32_16x16x32_bf16 v[20:23], v[164:167], v[56:59], v[20:23]
    v_mfma_f32_16x16x32_bf16 v[36:39], v[164:167], v[60:63], v[36:39]
    v_mfma_f32_16x16x32_bf16 v[24:27], v[168:171], v[56:59], v[24:27]
    v_mfma_f32_16x16x32_bf16 v[40:43], v[168:171], v[60:63], v[40:43]
    v_mfma_f32_16x16x32_bf16 v[28:31], v[172:175], v[56:59], v[28:31]
    v_mfma_f32_16x16x32_bf16 v[44:47], v[172:175], v[60:63], v[44:47]
    s_cmp_ge_u32 s3, 2
    s_cbranch_scc1 L_k_nol1
    v_mfma_f32_16x16x32_bf16 v[116:119], v[112:115], v[48:51], 0
    v_mfma_f32_16x16x32_bf16 v[120:123], v[112:115], v[52:55], 0
    v_mfma_f32_16x16x32_bf16 v[116:119], v[112:115], v[56:59], v[116:119]
    v_mfma_f32_16x16x32_bf16 v[120:123], v[112:115], v[60:63], v[120:123]
L_k_nol1:
    s_waitcnt lgkmcnt(0)
    s_barrier
    ds_read_b32 v15, v251
    ds_read_b128 v[64:67], v9 offset:5120
    ds_read_b128 v[68:71], v9 offset:6400
    ds_read_b128 v[72:75], v9 offset:7680
    ds_read_b128 v[76:79], v9 offset:8960
    s_branch L_k_join
    .p2align 3
L_k_late:
    s_cmp_lg_u32 s3, 7
    s_cbranch_scc1 L_k_notrig
    v_mov_b32 v243, s29
    s_mov_b64 exec, 1
    buffer_store_dword v243, v12, s[40:43], s90 offen sc1
    s_mov_b64 exec, -1
L_k_notrig:
    buffer_load_dword v247, v247, s[56:59], s88 offen
    ds_read_b128 v[208:211], v6 offset:0
    ds_read_b128 v[212:215], v6 offset:64
    ds_read_b128 v[216:219], v6 offset:128
    ds_read_b128 v[220:223], v6 offset:192
    ds_read_b128 v[224:227], v6 offset:256
    s_barrier
    s_waitcnt lgkmcnt(4)
    v_mfma_f32_16x16x32_bf16 v[232:235], v[16:19], v[208:211], 0
    ds_read_b128 v[228:231], v6 offset:320
    s_waitcnt lgkmcnt(4)
    v_mfma_f32_16x16x32_bf16 v[232:235], v[20:23], v[212:215], v[232:235]
    ds_read_b128 v[208:211], v6 offset:384
    s_waitcnt lgkmcnt(4)
    v_mfma_f32_16x16x32_bf16 v[232:235], v[24:27], v[216:219], v[232:235]
    ds_read_b128 v[212:215], v6 offset:448
    s_waitcnt lgkmcnt(4)
    v_mfma_f32_16x16x32_bf16 v[232:235], v[28:31], v[220:223], v[232:235]
    ds_read_b128 v[216:219], v6 offset:512
    s_waitcnt lgkmcnt(4)
    v_mfma_f32_16x16x32_bf16 v[232:235], v[32:35], v[224:227], v[232:235]
    ds_read_b128 v[220:223], v6 offset:576
    s_waitcnt lgkmcnt(4)
    v_mfma_f32_16x16x32_bf16 v[232:235], v[36:39], v[228:231], v[232:235]
    ds_read_b128 v[224:227], v6 offset:640
    s_waitcnt lgkmcnt(4)
    v_mfma_f32_16x16x32_bf16 v[232:235], v[40:43], v[208:211], v[232:235]
    ds_read_b128 v[228:231], v6 offset:704
    s_waitcnt lgkmcnt(4)
    v_mfma_f32_16x16x32_bf16 v[232:235], v[44:47], v[212:215], v[232:235]
    ds_read_b128 v[208:211], v6 offset:768
    s_waitcnt lgkmcnt(4)
    v_mfma_f32_16x16x32_bf16 v[232:235], v[48:51], v[216:219], v[232:235]
    ds_read_b128 v[212:215], v6 offset:832
    s_waitcnt lgkmcnt(4)
    v_mfma_f32_16x16x32_bf16 v[232:235], v[52:55], v[220:223], v[232:235]
    ds_read_b128 v[216:219], v6 offset:896
    s_waitcnt lgkmcnt(4)
    v_mfma_f32_16x16x32_bf16 v[232:235], v[56:59], v[224:227], v[232:235]
    ds_read_b128 v[220:223], v6 offset:960
    s_waitcnt lgkmcnt(4)
    v_mfma_f32_16x16x32_bf16 v[232:235], v[60:63], v[228:231], v[232:235]
    s_waitcnt lgkmcnt(3)
    v_mfma_f32_16x16x32_bf16 v[232:235], v[64:67], v[208:211], v[232:235]
    s_waitcnt lgkmcnt(2)
    v_mfma_f32_16x16x32_bf16 v[232:235], v[68:71], v[212:215], v[232:235]
    s_waitcnt lgkmcnt(1)
    v_mfma_f32_16x16x32_bf16 v[232:235], v[72:75], v[216:219], v[232:235]
    s_waitcnt lgkmcnt(0)
    v_mfma_f32_16x16x32_bf16 v[232:235], v[76:79], v[220:223], v[232:235]
    ds_read_b64 v[240:241], v253
    s_waitcnt lgkmcnt(0)
    v_max_f32 v246, v240, v241
    v_ceil_f32 v13, v246
    v_add_f32 v248, 0x41800000, v13
    s_waitcnt vmcnt(1)
    s_barrier
    s_setprio 1
    ds_read_b128 v[80:83], v249 offset:33792
    ds_read_b128 v[208:211], v6 offset:0
    ds_read_b128 v[84:87], v249 offset:33856
    ds_read_b128 v[212:215], v6 offset:64
    ds_read_b128 v[88:91], v249 offset:33920
    ds_read_b128 v[216:219], v6 offset:128
    ds_read_b128 v[92:95], v249 offset:33984
    ds_read_b128 v[220:223], v6 offset:192
    ds_read_b128 v[96:99], v249 offset:34048
    ds_read_b128 v[224:227], v6 offset:256
    v_sub_f32 v64, v232, v13
    v_sub_f32 v65, v233, v13
    v_sub_f32 v66, v234, v13
    v_sub_f32 v67, v235, v13
    v_exp_f32 v64, v64
    v_exp_f32 v65, v65
    v_exp_f32 v66, v66
    v_exp_f32 v67, v67
    v_cvt_pk_bf16_f32 v68, v64, v65
    v_cvt_pk_bf16_f32 v69, v66, v67
    v_max3_f32 v246, v232, v233, v234
    v_max_f32 v246, v246, v235
    s_waitcnt lgkmcnt(8)
    v_mfma_f32_16x16x32_bf16 v[236:239], v[80:83], v[208:211], 0
    ds_read_b128 v[100:103], v249 offset:34112
    ds_read_b128 v[228:231], v6 offset:320
    s_waitcnt lgkmcnt(8)
    v_mfma_f32_16x16x32_bf16 v[236:239], v[84:87], v[212:215], v[236:239]
    ds_read_b128 v[104:107], v249 offset:34176
    ds_read_b128 v[208:211], v6 offset:384
    s_waitcnt lgkmcnt(8)
    v_mfma_f32_16x16x32_bf16 v[236:239], v[88:91], v[216:219], v[236:239]
    ds_read_b128 v[108:111], v249 offset:34240
    ds_read_b128 v[212:215], v6 offset:448
    s_waitcnt lgkmcnt(8)
    v_mfma_f32_16x16x32_bf16 v[236:239], v[92:95], v[220:223], v[236:239]
    ds_read_b128 v[112:115], v249 offset:34304
    ds_read_b128 v[216:219], v6 offset:512
    s_waitcnt lgkmcnt(8)
    v_mfma_f32_16x16x32_bf16 v[236:239], v[96:99], v[224:227], v[236:239]
    ds_read_b128 v[116:119], v249 offset:34368
    ds_read_b128 v[220:223], v6 offset:576
    s_waitcnt lgkmcnt(8)
    v_mfma_f32_16x16x32_bf16 v[236:239], v[100:103], v[228:231], v[236:239]
    ds_read_b128 v[120:123], v249 offset:34432
    ds_read_b128 v[224:227], v6 offset:640
    s_waitcnt lgkmcnt(8)
    v_mfma_f32_16x16x32_bf16 v[236:239], v[104:107], v[208:211], v[236:239]
    ds_read_b128 v[124:127], v249 offset:34496
    ds_read_b128 v[228:231], v6 offset:704
    s_waitcnt lgkmcnt(8)
    v_mfma_f32_16x16x32_bf16 v[236:239], v[108:111], v[212:215], v[236:239]
    ds_read_b128 v[128:131], v249 offset:34560
    ds_read_b128 v[208:211], v6 offset:768
    s_waitcnt lgkmcnt(8)
    v_mfma_f32_16x16x32_bf16 v[236:239], v[112:115], v[216:219], v[236:239]
    ds_read_b128 v[132:135], v249 offset:34624
    ds_read_b128 v[212:215], v6 offset:832
    s_waitcnt lgkmcnt(8)
    v_mfma_f32_16x16x32_bf16 v[236:239], v[116:119], v[220:223], v[236:239]
    ds_read_b128 v[136:139], v249 offset:34688
    ds_read_b128 v[216:219], v6 offset:896
    s_waitcnt lgkmcnt(8)
    v_mfma_f32_16x16x32_bf16 v[236:239], v[120:123], v[224:227], v[236:239]
    ds_read_b128 v[140:143], v249 offset:34752
    ds_read_b128 v[220:223], v6 offset:960
    s_waitcnt lgkmcnt(8)
    v_mfma_f32_16x16x32_bf16 v[236:239], v[124:127], v[228:231], v[236:239]
    s_waitcnt lgkmcnt(6)
    v_mfma_f32_16x16x32_bf16 v[236:239], v[128:131], v[208:211], v[236:239]
    s_waitcnt lgkmcnt(4)
    v_mfma_f32_16x16x32_bf16 v[236:239], v[132:135], v[212:215], v[236:239]
    s_waitcnt lgkmcnt(2)
    v_mfma_f32_16x16x32_bf16 v[236:239], v[136:139], v[216:219], v[236:239]
    s_waitcnt lgkmcnt(0)
    v_mfma_f32_16x16x32_bf16 v[236:239], v[140:143], v[220:223], v[236:239]
    ds_write_b64 v8, v[68:69] offset:0
    ds_read_b128 v[48:51], v9 offset:0
    ds_read_b128 v[52:55], v9 offset:1280
    ds_read_b128 v[56:59], v9 offset:2560
    ds_read_b128 v[60:63], v9 offset:3840
    s_nop 2
    v_max3_f32 v246, v246, v236, v237
    v_max3_f32 v246, v246, v238, v239
    v_cmp_gt_f32 vcc, v246, v248
    v_sub_f32 v208, v236, v13
    v_sub_f32 v209, v237, v13
    v_sub_f32 v210, v238, v13
    v_sub_f32 v211, v239, v13
    v_exp_f32 v208, v208
    v_exp_f32 v209, v209
    v_exp_f32 v210, v210
    v_exp_f32 v211, v211
    v_cvt_pk_bf16_f32 v212, v208, v209
    v_cvt_pk_bf16_f32 v213, v210, v211
    ds_write_b64 v8, v[212:213] offset:2560
    s_cbranch_vccz L_k_noex
    v_mov_b32 v15, 1
    ds_write_b32 v251, v15
L_k_noex:
    s_waitcnt lgkmcnt(0)
    s_barrier
    s_setprio 0
    ds_read_b32 v15, v251
    ds_read_b128 v[64:67], v9 offset:5120
    ds_read_b128 v[68:71], v9 offset:6400
    ds_read_b128 v[72:75], v9 offset:7680
    ds_read_b128 v[76:79], v9 offset:8960
    ds_read_b64_tr_b16 v[192:193], v254 offset:33792
    ds_read_b64_tr_b16 v[194:195], v254 offset:50688
    ds_read_b64_tr_b16 v[196:197], v254 offset:33824
    ds_read_b64_tr_b16 v[198:199], v254 offset:50720
    ds_read_b64_tr_b16 v[200:201], v254 offset:33856
    ds_read_b64_tr_b16 v[202:203], v254 offset:50752
    ds_read_b64_tr_b16 v[204:205], v254 offset:33888
    ds_read_b64_tr_b16 v[206:207], v254 offset:50784
    v_mfma_f32_16x16x32_bf16 v[16:19], v[144:147], v[48:51], 0
    v_mfma_f32_16x16x32_bf16 v[32:35], v[144:147], v[52:55], 0
    v_mfma_f32_16x16x32_bf16 v[20:23], v[148:151], v[48:51], 0
    v_mfma_f32_16x16x32_bf16 v[36:39], v[148:151], v[52:55], 0
    v_mfma_f32_16x16x32_bf16 v[24:27], v[152:155], v[48:51], 0
    v_mfma_f32_16x16x32_bf16 v[40:43], v[152:155], v[52:55], 0
    v_mfma_f32_16x16x32_bf16 v[28:31], v[156:159], v[48:51], 0
    v_mfma_f32_16x16x32_bf16 v[44:47], v[156:159], v[52:55], 0
    v_mfma_f32_16x16x32_bf16 v[16:19], v[160:163], v[56:59], v[16:19]
    v_mfma_f32_16x16x32_bf16 v[32:35], v[160:163], v[60:63], v[32:35]
    v_mfma_f32_16x16x32_bf16 v[20:23], v[164:167], v[56:59], v[20:23]
    v_mfma_f32_16x16x32_bf16 v[36:39], v[164:167], v[60:63], v[36:39]
    v_mfma_f32_16x16x32_bf16 v[24:27], v[168:171], v[56:59], v[24:27]
    v_mfma_f32_16x16x32_bf16 v[40:43], v[168:171], v[60:63], v[40:43]
    v_mfma_f32_16x16x32_bf16 v[28:31], v[172:175], v[56:59], v[28:31]
    v_mfma_f32_16x16x32_bf16 v[44:47], v[172:175], v[60:63], v[44:47]
L_k_join:
    s_waitcnt lgkmcnt(4)
    v_cmp_ne_u32 vcc, 0, v15
    s_cbranch_vccnz L_k_slow
L_k_slowret:
    s_cmp_ge_u32 s3, 2
    s_cbranch_scc1 L_k_nost
    s_waitcnt lgkmcnt(0)
    v_mfma_f32_16x16x32_bf16 v[116:119], v[112:115], v[64:67], v[116:119]
    v_mfma_f32_16x16x32_bf16 v[120:123], v[112:115], v[68:71], v[120:123]
    v_mfma_f32_16x16x32_bf16 v[116:119], v[112:115], v[72:75], v[116:119]
    v_mfma_f32_16x16x32_bf16 v[120:123], v[112:115], v[76:79], v[120:123]
L_k_nost:
    s_waitcnt lgkmcnt(0)
    v_mfma_f32_16x16x32_bf16 v[16:19], v[176:179], v[64:67], v[16:19]
    v_mfma_f32_16x16x32_bf16 v[20:23], v[180:183], v[64:67], v[20:23]
    v_mfma_f32_16x16x32_bf16 v[16:19], v[192:195], v[72:75], v[16:19]
    v_mfma_f32_16x16x32_bf16 v[20:23], v[196:199], v[72:75], v[20:23]
    v_mfma_f32_16x16x32_bf16 v[24:27], v[184:187], v[64:67], v[24:27]
    v_mfma_f32_16x16x32_bf16 v[28:31], v[188:191], v[64:67], v[28:31]
    v_mfma_f32_16x16x32_bf16 v[24:27], v[200:203], v[72:75], v[24:27]
    v_mfma_f32_16x16x32_bf16 v[28:31], v[204:207], v[72:75], v[28:31]
    s_nop 2
    v_cvt_pk_bf16_f32 v80, v16, v17
    v_cvt_pk_bf16_f32 v82, v20, v21
    v_cvt_pk_bf16_f32 v81, v18, v19
    v_mfma_f32_16x16x32_bf16 v[32:35], v[176:179], v[68:71], v[32:35]
    v_cvt_pk_bf16_f32 v83, v22, v23
    v_permlane16_swap_b32 v80, v82
    s_nop 0
    v_permlane16_swap_b32 v81, v83
    v_mfma_f32_16x16x32_bf16 v[36:39], v[180:183], v[68:71], v[36:39]
    ds_write_b128 v4, v[80:83] offset:0
    v_mfma_f32_16x16x32_bf16 v[32:35], v[192:195], v[76:79], v[32:35]
    v_cvt_pk_bf16_f32 v84, v24, v25
    v_cvt_pk_bf16_f32 v86, v28, v29
    v_cvt_pk_bf16_f32 v85, v26, v27
    v_mfma_f32_16x16x32_bf16 v[36:39], v[196:199], v[76:79], v[36:39]
    v_cvt_pk_bf16_f32 v87, v30, v31
    v_permlane16_swap_b32 v84, v86
    s_nop 0
    v_permlane16_swap_b32 v85, v87
    v_mfma_f32_16x16x32_bf16 v[40:43], v[184:187], v[68:71], v[40:43]
    ds_write_b128 v5, v[84:87] offset:0
    v_mfma_f32_16x16x32_bf16 v[44:47], v[188:191], v[68:71], v[44:47]
    s_waitcnt lgkmcnt(0)
    ds_read_b128 v[96:99], v10 offset:0
    ds_read_b128 v[100:103], v10 offset:1024
    v_mfma_f32_16x16x32_bf16 v[40:43], v[200:203], v[76:79], v[40:43]
    v_cvt_pk_bf16_f32 v88, v32, v33
    v_cvt_pk_bf16_f32 v90, v36, v37
    v_cvt_pk_bf16_f32 v89, v34, v35
    v_cvt_pk_bf16_f32 v91, v38, v39
    v_mfma_f32_16x16x32_bf16 v[44:47], v[204:207], v[76:79], v[44:47]
    v_permlane16_swap_b32 v88, v90
    v_permlane16_swap_b32 v89, v91
    ds_write_b128 v4, v[88:91] offset:2048
    s_waitcnt lgkmcnt(1)
    buffer_store_dwordx4 v[96:99], v11, s[40:43], s60 offen sc1
    buffer_store_dwordx4 v[100:103], v11, s[40:43], s61 offen sc1
    v_cvt_pk_bf16_f32 v92, v40, v41
    s_nop 0
    v_cvt_pk_bf16_f32 v94, v44, v45
    v_cvt_pk_bf16_f32 v93, v42, v43
    v_cvt_pk_bf16_f32 v95, v46, v47
    v_permlane16_swap_b32 v92, v94
    s_nop 0
    v_permlane16_swap_b32 v93, v95
    ds_write_b128 v5, v[92:95] offset:2048
    s_waitcnt lgkmcnt(0)
    ds_read_b128 v[104:107], v10 offset:2048
    ds_read_b128 v[108:111], v10 offset:3072
    s_waitcnt lgkmcnt(1)
    buffer_store_dwordx4 v[104:107], v11, s[40:43], s62 offen sc1
    s_waitcnt lgkmcnt(0)
    buffer_store_dwordx4 v[108:111], v11, s[40:43], s63 offen sc1
    s_cmp_eq_u32 s3, 1
    s_cselect_b64 vcc, -1, 0
    s_lshl_b32 s69, s28, 9
    s_lshl_b32 s37, s3, 8
    s_add_u32 s69, s69, s37
    s_add_u32 s69, s69, 1835008
    v_mov_b32 v240, v13
    v_mov_b32 v241, s29
    v_cndmask_b32 v242, v116, v120, vcc
    v_mov_b32 v243, s29
    s_waitcnt vmcnt(0)
    s_barrier
    s_cmp_ge_u32 s3, 2
    s_cbranch_scc1 L_k_nohint
    s_mov_b64 exec, 0xffff
    buffer_store_dwordx4 v[240:243], v12, s[40:43], s69 offen sc1
    s_mov_b64 exec, -1
L_k_nohint:
    v_lshrrev_b32 v252, 1, v1
    v_mul_u32_u24 v252, 0xd80, v252
    v_and_b32 v15, 1, v1
    v_lshl_add_u32 v252, v15, 4, v252
    s_barrier
    s_cmp_ge_u32 s28, 108
    s_cbranch_scc1 L_k_ffn_ldd
    s_add_u32 m0, s75, 67584
    s_nop 0
    buffer_load_dwordx4 v252, s[52:55], s74 offen lds
    s_mov_b32 m0, s77
    s_nop 0
    buffer_load_dwordx4 v12, s[56:59], s76 offen lds
    s_add_u32 m0, s75, 75776
    s_add_u32 s74, s74, 884736
    buffer_load_dwordx4 v252, s[52:55], s74 offen lds
    s_mov_b32 m0, s78
    s_add_u32 s76, s76, 8192
    buffer_load_dwordx4 v12, s[56:59], s76 offen lds
    s_cmp_ge_u32 s3, 4
    s_cbranch_scc1 L_k_ffn_ldd
    s_add_u32 m0, s75, 83968
    s_add_u32 s74, s74, 884736
    buffer_load_dwordx4 v252, s[52:55], s74 offen lds
    s_mov_b32 m0, s79
    s_add_u32 s76, s76, 8192
    buffer_load_dwordx4 v12, s[56:59], s76 offen lds
L_k_ffn_ldd:
    v_mov_b32 v88, 0
    v_mov_b32 v89, 0
    v_mov_b32 v90, 0
    v_mov_b32 v91, 0
    v_mov_b32 v92, 0
    v_mov_b32 v93, 0
    v_mov_b32 v94, 0
    v_mov_b32 v95, 0
    v_mov_b32 v96, 0
    v_mov_b32 v97, 0
    v_mov_b32 v98, 0
    v_mov_b32 v99, 0
    v_mov_b32 v100, 0
    v_mov_b32 v101, 0
    v_mov_b32 v102, 0
    v_mov_b32 v103, 0
    v_mov_b32 v104, 0
    v_mov_b32 v105, 0
    v_mov_b32 v106, 0
    v_mov_b32 v107, 0
    v_and_b32 v250, 1, v1
    v_and_b32 v6, 12, v2
    v_add_u32 v6, v6, v3
    v_lshlrev_b32 v21, 13, v6
    v_and_b32 v7, 3, v2
    v_lshl_add_u32 v21, v7, 4, v21
    s_lshl_b32 s36, s3, 17
    s_lshl_b32 s37, s28, 6
    s_add_u32 s36, s36, s37
    s_add_u32 s36, s36, 1179648
    s_cmp_ge_u32 s28, 108
    s_cbranch_scc1 L_k_noffn
    v_lshrrev_b32 v6, 2, v2
    v_and_b32 v7, 1, v3
    v_lshl_add_u32 v6, v7, 2, v6
    v_mul_u32_u24 v40, 0x500, v6
    v_and_b32 v7, 3, v2
    v_lshl_add_u32 v40, v7, 4, v40
    v_lshrrev_b32 v7, 1, v3
    v_mul_u32_u24 v7, 62720, v7
    s_lshl_b32 s37, s3, 8
    s_min_u32 s37, s37, 1024
    s_add_u32 s37, s37, 88064
    v_add3_u32 v40, v40, v7, s37
    s_add_u32 s37, s75, 67584
    v_lshl_add_u32 v6, v1, 3, s37
    v_lshlrev_b32 v28, 4, v3
    s_lshl_b32 s37, s3, 6
    s_add_u32 s32, s37, 147520
    v_add_u32 v8, s32, v28
    v_add_u32 v28, 150144, v28
    v_add_u32 v9, s37, v28
    ds_read_b128 v[68:71], v8 offset:0
    ds_read_b128 v[72:75], v8 offset:512
    ds_read_b128 v[76:79], v8 offset:1024
    s_waitcnt vmcnt(0)
    s_barrier
    ds_read_b64_tr_b16 v[48:49], v6 offset:0
    ds_read_b64_tr_b16 v[50:51], v6 offset:512
    ds_read_b64_tr_b16 v[52:53], v6 offset:8192
    ds_read_b64_tr_b16 v[54:55], v6 offset:8704
    ds_read_b64_tr_b16 v[56:57], v6 offset:16384
    ds_read_b64_tr_b16 v[58:59], v6 offset:16896
    ds_read_b64_tr_b16 v[144:145], v40 offset:0
    ds_read_b64_tr_b16 v[146:147], v40 offset:8
    ds_read_b64_tr_b16 v[148:149], v40 offset:64
    ds_read_b64_tr_b16 v[150:151], v40 offset:72
    ds_read_b64_tr_b16 v[152:153], v40 offset:128
    ds_read_b64_tr_b16 v[154:155], v40 offset:136
    ds_read_b64_tr_b16 v[156:157], v40 offset:192
    ds_read_b64_tr_b16 v[158:159], v40 offset:200
    s_waitcnt lgkmcnt(8)
    v_mfma_f32_16x16x32_bf16 v[32:35], v[48:51], v[68:71], 0
    v_mfma_f32_16x16x32_bf16 v[32:35], v[52:55], v[72:75], v[32:35]
    s_cmp_ge_u32 s3, 4
    s_cbranch_scc1 L_k_f1x
    v_mfma_f32_16x16x32_bf16 v[32:35], v[56:59], v[76:79], v[32:35]
L_k_f1x:
    s_mov_b32 exec_lo, 0x00010001
    s_mov_b32 exec_hi, 0x00010001
    s_nop 5
    ds_write_b128 v9, v[32:35]
    s_mov_b64 exec, -1
    s_waitcnt lgkmcnt(0)
    s_barrier
    s_cmp_ge_u32 s3, 5
    s_cbranch_scc1 L_fin
    ds_read_b128 v[48:51], v28 offset:0
    ds_read_b128 v[52:55], v28 offset:64
    ds_read_b128 v[56:59], v28 offset:128
    ds_read_b128 v[60:63], v28 offset:192
    ds_read_b128 v[64:67], v28 offset:256
    ds_read_b128 v[68:71], v28 offset:320
    ds_read_b128 v[72:75], v28 offset:384
    ds_read_b128 v[76:79], v28 offset:448
    s_waitcnt lgkmcnt(0)
    v_pk_add_f32 v[48:49], v[48:49], v[64:65]
    v_pk_add_f32 v[50:51], v[50:51], v[66:67]
    v_pk_add_f32 v[52:53], v[52:53], v[68:69]
    v_pk_add_f32 v[54:55], v[54:55], v[70:71]
    v_pk_add_f32 v[56:57], v[56:57], v[72:73]
    v_pk_add_f32 v[58:59], v[58:59], v[74:75]
    v_pk_add_f32 v[60:61], v[60:61], v[76:77]
    v_pk_add_f32 v[62:63], v[62:63], v[78:79]
    v_pk_add_f32 v[48:49], v[48:49], v[56:57]
    v_pk_add_f32 v[50:51], v[50:51], v[58:59]
    v_pk_add_f32 v[52:53], v[52:53], v[60:61]
    v_pk_add_f32 v[54:55], v[54:55], v[62:63]
    v_pk_add_f32 v[48:49], v[48:49], v[52:53]
    v_pk_add_f32 v[50:51], v[50:51], v[54:55]
    v_max_f32 v48, 0, v48
    v_max_f32 v49, 0, v49
    v_max_f32 v50, 0, v50
    v_max_f32 v51, 0, v51
    s_mov_b32 exec_lo, 0x30003
    s_mov_b32 exec_hi, 0x30003
    v_cvt_pk_bf16_f32 v92, v48, v49
    v_cvt_pk_bf16_f32 v93, v50, v51
    s_mov_b32 exec_lo, 0xc000c
    s_mov_b32 exec_hi, 0xc000c
    v_cvt_pk_bf16_f32 v94, v48, v49
    v_cvt_pk_bf16_f32 v95, v50, v51
    s_mov_b32 exec_lo, 0x300030
    s_mov_b32 exec_hi, 0x300030
    v_cvt_pk_bf16_f32 v96, v48, v49
    v_cvt_pk_bf16_f32 v97, v50, v51
    s_mov_b32 exec_lo, 0xc000c0
    s_mov_b32 exec_hi, 0xc000c0
    v_cvt_pk_bf16_f32 v98, v48, v49
    v_cvt_pk_bf16_f32 v99, v50, v51
    s_mov_b32 exec_lo, 0x3000300
    s_mov_b32 exec_hi, 0x3000300
    v_cvt_pk_bf16_f32 v100, v48, v49
    v_cvt_pk_bf16_f32 v101, v50, v51
    s_mov_b32 exec_lo, 0xc000c00
    s_mov_b32 exec_hi, 0xc000c00
    v_cvt_pk_bf16_f32 v102, v48, v49
    v_cvt_pk_bf16_f32 v103, v50, v51
    s_mov_b32 exec_lo, 0x30003000
    s_mov_b32 exec_hi, 0x30003000
    v_cvt_pk_bf16_f32 v104, v48, v49
    v_cvt_pk_bf16_f32 v105, v50, v51
    s_mov_b32 exec_lo, 0xc000c000
    s_mov_b32 exec_hi, 0xc000c000
    v_cvt_pk_bf16_f32 v106, v48, v49
    v_cvt_pk_bf16_f32 v107, v50, v51
    s_mov_b64 exec, -1
    v_mfma_f32_16x16x16_bf16 v[88:91], v[144:145], v[92:93], v[88:91]
    v_mfma_f32_16x16x16_bf16 v[88:91], v[146:147], v[94:95], v[88:91]
    v_mfma_f32_16x16x16_bf16 v[88:91], v[148:149], v[96:97], v[88:91]
    v_mfma_f32_16x16x16_bf16 v[88:91], v[150:151], v[98:99], v[88:91]
    v_mfma_f32_16x16x16_bf16 v[88:91], v[152:153], v[100:101], v[88:91]
    v_mfma_f32_16x16x16_bf16 v[88:91], v[154:155], v[102:103], v[88:91]
    v_mfma_f32_16x16x16_bf16 v[88:91], v[156:157], v[104:105], v[88:91]
    v_mfma_f32_16x16x16_bf16 v[88:91], v[158:159], v[106:107], v[88:91]
L_k_noffn:
    s_cmp_ge_u32 s3, 5
    s_cbranch_scc1 L_fin
    s_mov_b32 vcc_lo, 0xaaaaaaaa
    s_mov_b32 vcc_hi, 0xaaaaaaaa
    v_mov_b32 v57, s29
    v_mov_b32 v59, s29
    s_nop 1
    v_cndmask_b32 v56, v88, v90, vcc
    v_cndmask_b32 v58, v89, v91, vcc
    buffer_store_dwordx4 v[56:59], v21, s[40:43], s36 offen sc1
    s_cmp_ge_u32 s28, 80
    s_cbranch_scc1 L_fin
    s_mov_b32 s44, s4
    s_and_b32 s45, s5, 0xffff
    s_mov_b32 s46, 1280
    s_mov_b32 s48, s22
    s_and_b32 s49, s23, 0xffff
    s_mov_b32 s50, 1280
    v_and_b32 v240, 3, v2
    v_lshlrev_b32 v240, 2, v240
    v_and_b32 v242, 2, v3
    v_add_u32 v240, v240, v242
    s_lshl_b32 s34, s28, 4
    buffer_load_ushort v241, v240, s[44:47], s34 offen
    v_add_u32 v243, 135168, v12
    s_lshl_b32 s37, s3, 2
    v_add_u32 v242, s37, v243
    s_cmp_eq_u32 s3, 4
    s_cbranch_scc0 L_k_sq
    s_lshl_b32 s68, s28, 13
    s_add_u32 s68, s68, 1179648
    s_add_u32 s69, s68, 4096
    s_lshl_b32 s70, s28, 7
    s_add_u32 s70, s70, 491520
L_k_ryg:
    s_load_dword s71, s[26:27], s70 glc
    s_waitcnt lgkmcnt(0)
    s_cmp_lg_u32 s71, s29
    s_cbranch_scc0 L_k_rygok
    s_sub_u32 s39, s39, 1
    s_cbranch_scc0 L_k_ryg
    s_mov_b32 s39, 0
L_k_rygok:
L_k_ry:
    buffer_load_dwordx4 v[16:19], v12, s[40:43], s68 offen offset:0 sc1
    buffer_load_dwordx4 v[20:23], v12, s[40:43], s68 offen offset:1024 sc1
    buffer_load_dwordx4 v[24:27], v12, s[40:43], s68 offen offset:2048 sc1
    buffer_load_dwordx4 v[28:31], v12, s[40:43], s68 offen offset:3072 sc1
    buffer_load_dwordx4 v[32:35], v12, s[40:43], s69 offen offset:0 sc1
    buffer_load_dwordx4 v[36:39], v12, s[40:43], s69 offen offset:1024 sc1
    buffer_load_dwordx4 v[40:43], v12, s[40:43], s69 offen offset:2048 sc1
    buffer_load_dwordx4 v[44:47], v12, s[40:43], s69 offen offset:3072 sc1
    s_mov_b64 exec, -1
    s_waitcnt vmcnt(0)
    v_xor_b32 v48, s29, v17
    v_xor_b32 v49, s29, v19
    v_xor_b32 v50, s29, v21
    v_xor_b32 v51, s29, v23
    v_xor_b32 v52, s29, v25
    v_xor_b32 v53, s29, v27
    v_xor_b32 v54, s29, v29
    v_xor_b32 v55, s29, v31
    v_xor_b32 v56, s29, v33
    v_xor_b32 v57, s29, v35
    v_xor_b32 v58, s29, v37
    v_xor_b32 v59, s29, v39
    v_xor_b32 v60, s29, v41
    v_xor_b32 v61, s29, v43
    v_xor_b32 v62, s29, v45
    v_xor_b32 v63, s29, v47
    v_or3_b32 v48, v48, v49, v50
    v_or3_b32 v51, v51, v52, v53
    v_or3_b32 v54, v54, v55, v56
    v_or3_b32 v57, v57, v58, v59
    v_or3_b32 v60, v60, v61, v62
    v_or3_b32 v48, v48, v51, v54
    v_or3_b32 v57, v57, v60, v63
    v_or_b32 v48, v48, v57
    v_cmp_ne_u32 vcc, 0, v48
    s_nop 0
    s_cmp_lg_u64 vcc, 0
    s_cbranch_scc0 L_k_ryok
    s_mov_b64 exec, vcc
    s_cbranch_scc0 L_k_ryok
    s_sub_u32 s39, s39, 1
    s_cbranch_scc0 L_k_ry
    s_mov_b32 s39, 0
L_k_ryok:
    s_mov_b64 exec, -1
    v_add_f32 v16, v16, v32
    v_add_f32 v18, v18, v34
    v_add_f32 v20, v20, v36
    v_add_f32 v22, v22, v38
    v_add_f32 v24, v24, v40
    v_add_f32 v26, v26, v42
    v_add_f32 v28, v28, v44
    v_add_f32 v30, v30, v46
    v_add_f32 v16, v16, v24
    v_add_f32 v18, v18, v26
    v_add_f32 v20, v20, v28
    v_add_f32 v22, v22, v30
    v_add_f32 v16, v16, v20
    v_add_f32 v18, v18, v22
    s_nop 1
    v_permlane32_swap_b32 v16, v18
    v_add_f32 v16, v16, v18
    v_mov_b32 v18, v16
    s_nop 1
    v_permlane16_swap_b32 v16, v18
    v_add_f32 v16, v16, v18
    s_nop 1
    v_add_f32 v16, v16, v16 row_ror:4 row_mask:0xf bank_mask:0xf
    s_nop 1
    v_add_f32 v16, v16, v16 row_ror:8 row_mask:0xf bank_mask:0xf
    v_cvt_pk_bf16_f32 v66, v16, v16
    v_and_b32 v66, 0xffff0000, v66
    v_mul_f32 v65, 0xbfb8aa3b, v66
    v_exp_f32 v65, v65
    s_nop 0
    v_add_f32 v65, 1.0, v65
    v_rcp_f32 v65, v65
    s_nop 0
    v_mul_f32 v65, v66, v65
    v_cvt_pk_bf16_f32 v65, v65, v65
    v_and_b32 v65, 0xffff0000, v65
    ds_write_b32 v243, v65 offset:1024
    s_waitcnt lgkmcnt(0)
    s_barrier
    s_branch L_fin
L_k_sq:
    s_lshl_b32 s68, s28, 13
    s_add_u32 s68, s68, 524288
    s_lshl_b32 s37, s3, 11
    s_add_u32 s68, s68, s37
    s_and_b32 s70, s28, 31
    s_lshl_b32 s70, s70, 6
    s_add_u32 s70, s70, s68
    s_add_u32 s70, s70, 4
L_k_rsg:
    s_load_dword s71, s[26:27], s70 glc
    s_waitcnt lgkmcnt(0)
    s_cmp_lg_u32 s71, s29
    s_cbranch_scc0 L_k_rsgok
    s_sub_u32 s39, s39, 1
    s_cbranch_scc0 L_k_rsg
    s_mov_b32 s39, 0
L_k_rsgok:
L_k_rs:
    buffer_load_dwordx4 v[20:23], v12, s[40:43], s68 offen offset:0 sc1
    buffer_load_dwordx4 v[24:27], v12, s[40:43], s68 offen offset:1024 sc1
    s_mov_b64 exec, -1
    s_waitcnt vmcnt(0)
    v_add_f32 v16, v20, v24
    v_add_f32 v18, v22, v26
    v_xor_b32 v48, s29, v21
    v_xor_b32 v49, s29, v23
    v_xor_b32 v50, s29, v25
    v_xor_b32 v51, s29, v27
    v_or3_b32 v48, v48, v49, v50
    v_or_b32 v48, v48, v51
    v_cmp_ne_u32 vcc, 0, v48
    s_nop 0
    s_cmp_lg_u64 vcc, 0
    s_cbranch_scc0 L_k_rsok
    s_mov_b64 exec, vcc
    s_cbranch_scc0 L_k_rsok
    s_sub_u32 s39, s39, 1
    s_cbranch_scc0 L_k_rs
    s_mov_b32 s39, 0
L_k_rsok:
    s_mov_b64 exec, -1
    v_permlane32_swap_b32 v16, v18
    v_add_f32 v16, v16, v18
    v_mov_b32 v18, v16
    s_nop 1
    v_permlane16_swap_b32 v16, v18
    v_add_f32 v16, v16, v18
    s_nop 1
    v_add_f32 v16, v16, v16 row_ror:4 row_mask:0xf bank_mask:0xf
    s_nop 1
    v_add_f32 v16, v16, v16 row_ror:8 row_mask:0xf bank_mask:0xf
    ds_write_b32 v242, v16
    s_waitcnt lgkmcnt(0)
    s_barrier
    s_cmp_lg_u32 s3, 0
    s_cbranch_scc1 L_fin
    ds_read_b128 v[20:23], v243
    ds_read_b32 v65, v243 offset:1024
    v_lshlrev_b32 v241, 16, v241
    s_waitcnt lgkmcnt(0)
    v_add_f32 v20, v20, v21
    v_add_f32 v22, v22, v23
    v_add_f32 v20, v20, v22
    v_cvt_pk_bf16_f32 v66, v20, v20
    v_and_b32 v66, 0xffff0000, v66
    v_mul_f32 v18, v66, v65
    v_cvt_pk_bf16_f32 v18, v18, v18
    v_and_b32 v18, 0xffff0000, v18
    v_add_f32 v18, v18, v241
    v_cvt_pk_bf16_f32 v18, v18, v18
    s_mov_b32 exec_lo, 0x0000000f
    s_mov_b32 exec_hi, 0x0000000f
    buffer_store_short v18, v240, s[48:51], s34 offen
    s_cmp_lg_u32 s28, 0
    s_cbranch_scc1 L_fin
    s_mov_b64 exec, 1
    v_mov_b32 v16, s29
    buffer_store_dword v16, v12, s[40:43], 0 offen sc1
    s_branch L_fin
L_k_slow:
    s_waitcnt lgkmcnt(0)
    s_cmp_lt_u32 s3, 4
    s_cbranch_scc1 L_k_sl1
    v_mov_b32 v15, v246
    s_nop 1
    v_permlane16_swap_b32 v246, v15
    v_max_f32 v246, v246, v15
    v_mov_b32 v15, v246
    s_nop 1
    v_permlane32_swap_b32 v246, v15
    v_max_f32 v246, v246, v15
    ds_write_b32 v7, v246
    s_waitcnt lgkmcnt(0)
L_k_sl1:
    s_barrier
    ds_read_b64 v[240:241], v253 offset:8
    s_waitcnt lgkmcnt(0)
    v_max_f32 v246, v240, v241
    v_ceil_f32 v246, v246
    v_max_f32 v240, v246, v13
    v_sub_f32 v241, v13, v240
    v_exp_f32 v241, v241
    v_mov_b32 v13, v240
    ds_write_b32 v253, v241 offset:16
    s_cmp_lt_u32 s3, 4
    s_cbranch_scc1 L_k_sl2
    v_sub_f32 v208, v232, v13
    v_sub_f32 v209, v233, v13
    v_sub_f32 v210, v234, v13
    v_sub_f32 v211, v235, v13
    v_exp_f32 v208, v208
    v_exp_f32 v209, v209
    v_exp_f32 v210, v210
    v_exp_f32 v211, v211
    v_cvt_pk_bf16_f32 v212, v208, v209
    v_cvt_pk_bf16_f32 v213, v210, v211
    ds_write_b64 v8, v[212:213] offset:0
    v_sub_f32 v216, v236, v13
    v_sub_f32 v217, v237, v13
    v_sub_f32 v218, v238, v13
    v_sub_f32 v219, v239, v13
    v_exp_f32 v216, v216
    v_exp_f32 v217, v217
    v_exp_f32 v218, v218
    v_exp_f32 v219, v219
    v_cvt_pk_bf16_f32 v220, v216, v217
    v_cvt_pk_bf16_f32 v221, v218, v219
    ds_write_b64 v8, v[220:221] offset:2560
L_k_sl2:
    s_waitcnt lgkmcnt(0)
    s_barrier
    v_lshlrev_b32 v15, 5, v2
    v_add_u32 v15, 145424, v15
    ds_read2_b32 v[244:245], v15 offset0:0 offset1:128
    ds_read_b128 v[64:67], v9 offset:5120
    ds_read_b128 v[68:71], v9 offset:6400
    ds_read_b128 v[72:75], v9 offset:7680
    ds_read_b128 v[76:79], v9 offset:8960
    s_waitcnt lgkmcnt(0)
    v_mul_f32 v16, v244, v16
    v_mul_f32 v17, v244, v17
    v_mul_f32 v18, v244, v18
    v_mul_f32 v19, v244, v19
    v_mul_f32 v20, v244, v20
    v_mul_f32 v21, v244, v21
    v_mul_f32 v22, v244, v22
    v_mul_f32 v23, v244, v23
    v_mul_f32 v24, v244, v24
    v_mul_f32 v25, v244, v25
    v_mul_f32 v26, v244, v26
    v_mul_f32 v27, v244, v27
    v_mul_f32 v28, v244, v28
    v_mul_f32 v29, v244, v29
    v_mul_f32 v30, v244, v30
    v_mul_f32 v31, v244, v31
    v_mul_f32 v116, v244, v116
    v_mul_f32 v117, v244, v117
    v_mul_f32 v118, v244, v118
    v_mul_f32 v119, v244, v119
    v_mul_f32 v32, v245, v32
    v_mul_f32 v33, v245, v33
    v_mul_f32 v34, v245, v34
    v_mul_f32 v35, v245, v35
    v_mul_f32 v36, v245, v36
    v_mul_f32 v37, v245, v37
    v_mul_f32 v38, v245, v38
    v_mul_f32 v39, v245, v39
    v_mul_f32 v40, v245, v40
    v_mul_f32 v41, v245, v41
    v_mul_f32 v42, v245, v42
    v_mul_f32 v43, v245, v43
    v_mul_f32 v44, v245, v44
    v_mul_f32 v45, v245, v45
    v_mul_f32 v46, v245, v46
    v_mul_f32 v47, v245, v47
    v_mul_f32 v120, v245, v120
    v_mul_f32 v121, v245, v121
    v_mul_f32 v122, v245, v122
    v_mul_f32 v123, v245, v123
    s_branch L_k_slowret
L_fin:
L_end:
    s_endpgm
.section .rodata,"a"
.p2align 6
.amdhsa_kernel recurrent_scan__compressed_kv_cla__dense_activation_relu__decode_kernel
  .amdhsa_next_free_vgpr 256
  .amdhsa_next_free_sgpr 102
  .amdhsa_accum_offset 256
  .amdhsa_group_segment_fixed_size 0
  .amdhsa_kernarg_size 96
  .amdhsa_user_sgpr_count 2
  .amdhsa_user_sgpr_kernarg_segment_ptr 1
  .amdhsa_system_sgpr_workgroup_id_x 1
  .amdhsa_float_denorm_mode_32 3
.end_amdhsa_kernel
```
